```python
import torch

def _softmax(x, axis=-1):
    return torch.softmax(x, dim=axis)
def _gelu(x):
    return torch.nn.functional.gelu(x, approximate="tanh")
def _silu(x):
    return torch.nn.functional.silu(x)
def _sigmoid(x):
    return torch.sigmoid(x)
def _layernorm(x, axis=-1, eps=1e-5):
    m = x.mean(dim=axis, keepdim=True)
    v = x.var(dim=axis, keepdim=True, unbiased=False)
    return (x - m) / torch.sqrt(v + eps)
def _scatter_add(tgt, idx, src, axis=0):
    return tgt.clone().index_add_(axis, idx, src)
def _segment_sum(src, seg, n):
    out = torch.zeros((n,) + src.shape[1:], dtype=src.dtype)
    return out.index_add_(0, seg, src)
def _pad(x, pw):
    flat = tuple(v for pair in reversed(pw) for v in pair)
    return torch.nn.functional.pad(x, flat)

kernel_name = 'interleave_layers__compressed_kv_cla__mha_block_cached__decode'

def setup_inputs():

    _w = (lambda a: (lambda t: t.to(torch.bfloat16) if t.is_floating_point() else t)(torch.as_tensor(a)))
    def _A_setup():
        B, H, Sq, Sk, D, M = 1, 32, 1, 8192, 128, 640
        Dc = 4 * D
        return {
            "x": _w((lambda *s: torch.randn(*s, dtype=torch.bfloat16) * 0.05)(B, Sq, M)),
            "c_kv": _w((lambda *s: torch.randn(*s, dtype=torch.bfloat16) * 1.6)(B, Sk, Dc)),
            "w_q": _w((lambda *s: torch.randn(*s, dtype=torch.bfloat16) * 0.8)(M, H, D) * (M ** -0.5)),
            "w_uk": _w((lambda *s: torch.randn(*s, dtype=torch.bfloat16) * 0.8)(Dc, H, D) * (Dc ** -0.5)),
            "w_uv": _w((lambda *s: torch.randn(*s, dtype=torch.bfloat16) * 1.6)(Dc, H, D) * (Dc ** -0.5)),
            "w_o": _w((lambda *s: torch.randn(*s, dtype=torch.bfloat16) * 1.6)(H, D, M) * ((H * D) ** -0.5)),
        }
    _A_in = _A_setup()

    def _B_setup():
        B, Sq, D = 1, 1, 640
        H, Sk, Dh = 32, 8192, 128
        return {
            "x": _w((lambda *s: torch.randn(*s, dtype=torch.bfloat16) * 0.05)(B, Sq, D)),
            "k_cache": _w((lambda *s: torch.randn(*s, dtype=torch.bfloat16) * 3.2)(B, H, Sk, Dh)),
            "v_cache": _w((lambda *s: torch.randn(*s, dtype=torch.bfloat16) * 0.4)(B, H, Sk, Dh)),
            "wq": _w((lambda *s: torch.randn(*s, dtype=torch.bfloat16) * 3.2)(D, H * Dh) * (D ** -0.5)),
            "wo": _w((lambda *s: torch.randn(*s, dtype=torch.bfloat16) * 0.4)(H * Dh, D) * ((H * Dh) ** -0.5)),
        }
    _B_in = _B_setup()

    return {
        "A_x": _A_in["x"],
        "A_c_kv": _A_in["c_kv"],
        "A_w_q": _A_in["w_q"],
        "A_w_uk": _A_in["w_uk"],
        "A_w_uv": _A_in["w_uv"],
        "A_w_o": _A_in["w_o"],
        "B_x": _B_in["x"],
        "B_k_cache": _B_in["k_cache"],
        "B_v_cache": _B_in["v_cache"],
        "B_wq": _B_in["wq"],
        "B_wo": _B_in["wo"],
    }

def reference(A_x, A_c_kv, A_w_q, A_w_uk, A_w_uv, A_w_o, B_x, B_k_cache, B_v_cache, B_wq, B_wo):
    def _A_ref(x, c_kv, w_q, w_uk, w_uv, w_o):
        B, Sq, M = x.shape[0], x.shape[1], x.shape[2]
        Sk = c_kv.shape[1]
        H, D = w_q.shape[1], w_q.shape[2]
        q = torch.einsum("bqm,mhd->bhqd", x, w_q)
        k = torch.einsum("bkc,chd->bhkd", c_kv, w_uk)
        v = torch.einsum("bkc,chd->bhkd", c_kv, w_uv)
        scores = torch.einsum("bhqd,bhkd->bhqk", q, k) * (D ** -0.5)
        off = Sk - Sq
        qi = torch.arange(Sq)[:, None]
        kj = torch.arange(Sk)[None, :]
        cmask = kj <= (qi + off)
        scores = torch.where(cmask[None, None], scores, -1e9)
        p = _softmax(scores, axis=-1)
        ctx = torch.einsum("bhqk,bhkd->bhqd", p, v)
        return torch.einsum("bhqd,hdm->bqm", ctx, w_o)

    def _B_ref(x, k_cache, v_cache, wq, wo):
        B, Sq, D = x.shape
        H, Dh = 32, 128
        q = (lambda x, *d: x.permute(*d))((x @ wq).reshape(B, Sq, H, Dh), 0, 2, 1, 3)
        scores = torch.einsum("bhqd,bhkd->bhqk", q, k_cache) * (Dh ** -0.5)
        p = _softmax(scores, axis=-1)
        o = torch.einsum("bhqk,bhkd->bhqd", p, v_cache)
        return (lambda x, *d: x.permute(*d))(o, 0, 2, 1, 3).reshape(B, Sq, H * Dh) @ wo

    x = A_x
    x = x + _A_ref(_layernorm(x, axis=-1), A_c_kv, A_w_q, A_w_uk, A_w_uv, A_w_o)
    x = x + _B_ref(_layernorm(x, axis=-1), B_k_cache, B_v_cache, B_wq, B_wo)
    x = x + _A_ref(_layernorm(x, axis=-1), A_c_kv, A_w_q, A_w_uk, A_w_uv, A_w_o)
    x = x + _B_ref(_layernorm(x, axis=-1), B_k_cache, B_v_cache, B_wq, B_wo)
    return x
```

```asm
; @launch grid=(256,1,1) block=(256,1,1) lds=163840
.amdgcn_target "amdgcn-amd-amdhsa--gfx950"
.text
.globl interleave_layers__compressed_kv_cla__mha_block_cached__decode_kernel
.p2align 8
.type interleave_layers__compressed_kv_cla__mha_block_cached__decode_kernel,@function
interleave_layers__compressed_kv_cla__mha_block_cached__decode_kernel:
    s_cmp_ge_u32 s2, 256
    s_cbranch_scc1 L_end
    s_load_dwordx4 s[64:67], s[0:1], 0
    s_load_dwordx4 s[68:71], s[0:1], 16
    s_load_dwordx4 s[72:75], s[0:1], 32
    s_load_dwordx4 s[76:79], s[0:1], 56
    s_load_dwordx4 s[80:83], s[0:1], 72
    s_load_dwordx4 s[84:87], s[0:1], 88
    s_load_dwordx2 s[8:9], s[0:1], 104
    v_lshrrev_b32 v20, 6, v0
    v_and_b32 v21, 63, v0
    v_readfirstlane_b32 s5, v20
    s_and_b32 s3, s2, 31
    s_lshr_b32 s4, s2, 5
    s_and_b32 s98, s2, 7
    s_lshr_b32 s99, s2, 3
    s_and_b32 s59, s99, 1
    s_lshr_b32 s60, s99, 1
    s_lshl_b32 s92, s98, 4
    s_add_u32 s60, s60, s92
    v_lshlrev_b32 v0, 4, v21
    s_cmp_lg_u32 s5, 3
    s_cbranch_scc1 cpf_1
    s_getpc_b64 s[20:21]
L_pcx:
    s_mov_b32 s22, L_codeend-L_pcx
    s_mov_b32 s23, 0x20000
    v_lshlrev_b32 v22, 6, v21
    s_mov_b32 s92, 0
    buffer_load_dword v23, v22, s[20:23], s92 offen
    s_mov_b32 s92, 4096
    buffer_load_dword v23, v22, s[20:23], s92 offen
    s_mov_b32 s92, 8192
    buffer_load_dword v23, v22, s[20:23], s92 offen
    s_mov_b32 s92, 12288
    buffer_load_dword v23, v22, s[20:23], s92 offen
    s_mov_b32 s92, 16384
    buffer_load_dword v23, v22, s[20:23], s92 offen
    s_mov_b32 s92, 20480
    buffer_load_dword v23, v22, s[20:23], s92 offen
    s_mov_b32 s92, 24576
    buffer_load_dword v23, v22, s[20:23], s92 offen
cpf_1:
    v_and_b32 v22, 15, v21
    v_lshrrev_b32 v19, 4, v21
    v_lshlrev_b32 v24, 4, v22
    v_lshl_add_u32 v7, v19, 13, v24
    v_lshrrev_b32 v25, 1, v19
    v_and_b32 v26, 1, v19
    v_lshl_add_u32 v25, v25, 2, v26
    v_lshl_add_u32 v9, v25, 8, v24
    v_and_b32 v25, 3, v22
    v_lshl_add_u32 v25, v19, 2, v25
    v_lshlrev_b32 v25, 4, v25
    v_lshrrev_b32 v26, 2, v22
    v_lshl_add_u32 v8, v26, 8, v25
    v_and_b32 v25, 1, v22
    v_cmp_eq_u32 vcc, 1, v25
    v_mov_b32 v26, 0xffff
    v_mov_b32 v27, 0xffff0000
    v_cndmask_b32 v26, v26, v27, vcc
    v_lshrrev_b32 v25, 1, v22
    v_cmp_eq_u32 vcc, 0, v25
    s_nop 1
    v_cndmask_b32 v1, 0, v26, vcc
    v_cmp_eq_u32 vcc, 1, v25
    s_nop 1
    v_cndmask_b32 v2, 0, v26, vcc
    v_cmp_eq_u32 vcc, 2, v25
    s_nop 1
    v_cndmask_b32 v3, 0, v26, vcc
    v_cmp_eq_u32 vcc, 3, v25
    s_nop 1
    v_cndmask_b32 v4, 0, v26, vcc
    v_lshl_add_u32 v25, v22, 1, v19
    v_lshlrev_b32 v25, 4, v25
    v_cmp_gt_u32 vcc, 32, v21
    v_mov_b32 v26, 512
    s_nop 0
    v_cndmask_b32 v25, v26, v25, vcc
    s_mul_i32 s92, s5, 1056
    s_add_u32 s92, s92, 156160
    v_add_u32 v10, s92, v25
    v_mul_u32_u24 v25, 6554, v21
    v_lshrrev_b32 v25, 16, v25
    v_mul_u32_u24 v26, 10, v25
    v_sub_u32 v26, v21, v26
    v_mul_u32_u24 v25, 1280, v25
    v_lshl_add_u32 v13, v26, 4, v25
    s_waitcnt lgkmcnt(0)
    s_mov_b32 s10, 0x10000000
    s_mov_b32 s11, 0x20000
    v_mov_b32 v28, 0
    buffer_load_dword v5, v28, s[8:11], 0 offen sc1
    s_mov_b32 s56, s64
    s_mov_b32 s57, s65
    s_mov_b32 s24, s56
    s_mov_b32 s25, s57
    s_mov_b32 s26, 0x500
    s_mov_b32 s27, 0x20000
    s_mul_i32 s92, s4, 80
    s_mul_i32 s93, s5, 20
    s_add_u32 s92, s92, s93
    v_lshl_add_u32 v25, v22, 2, v19
    v_add_u32 v25, s92, v25
    v_lshlrev_b32 v29, 1, v25
    s_mov_b32 s94, 0x001f001f
    s_mov_b32 s95, 0x001f001f
    v_mov_b32 v6, 0
    s_mov_b64 exec, s[94:95]
    buffer_load_ushort v6, v29, s[24:27], 0 offen
    s_mov_b64 exec, -1
    s_mov_b32 s92, 0
    s_mul_i32 s93, s4, 655360
    s_add_u32 s92, s92, s93
    s_mul_i32 s93, s5, 163840
    s_add_u32 s92, s92, s93
    s_mul_i32 s93, s3, 256
    s_add_u32 s92, s92, s93
    s_add_u32 s40, s68, s92
    s_addc_u32 s41, s69, 0
    s_mov_b32 s6, 0
    s_bitcmp1_b32 s6, 0
    s_cbranch_scc1 wq_2
    s_mov_b32 s20, s40
    s_mov_b32 s21, s41
    s_branch wq_3
wq_2:
    s_mov_b32 s20, s42
    s_mov_b32 s21, s43
wq_3:
    s_mov_b32 s22, 155904
    s_mov_b32 s23, 0x20000
    s_mov_b32 s65, 0
    buffer_load_dwordx4 v[76:79], v7, s[20:23], s65 offen
    s_mov_b32 s65, 32768
    buffer_load_dwordx4 v[80:83], v7, s[20:23], s65 offen
    s_mov_b32 s65, 65536
    buffer_load_dwordx4 v[84:87], v7, s[20:23], s65 offen
    s_mov_b32 s65, 98304
    buffer_load_dwordx4 v[88:91], v7, s[20:23], s65 offen
    s_mov_b32 s65, 131072
    buffer_load_dwordx4 v[92:95], v7, s[20:23], s65 offen
    s_mov_b32 s92, 0
    s_mul_i32 s93, s4, 524288
    s_add_u32 s92, s92, s93
    s_mul_i32 s93, s5, 131072
    s_add_u32 s92, s92, s93
    s_mul_i32 s93, s3, 256
    s_add_u32 s92, s92, s93
    s_add_u32 s44, s70, s92
    s_addc_u32 s45, s71, 0
    s_mov_b32 s64, 0xff
    s_mov_b32 s20, s44
    s_mov_b32 s21, s45
    s_mov_b32 s22, 0x1e100
    s_mov_b32 s23, 0x20000
    v_lshrrev_b32 v11, 8, v8
    v_lshlrev_b32 v11, 13, v11
    v_and_b32 v12, s64, v8
    v_or_b32 v11, v11, v12
    s_mov_b32 s65, 0
    buffer_load_dwordx4 v[60:63], v11, s[20:23], s65 offen
    s_mov_b32 s65, 32768
    buffer_load_dwordx4 v[64:67], v11, s[20:23], s65 offen
    s_mov_b32 s65, 65536
    buffer_load_dwordx4 v[68:71], v11, s[20:23], s65 offen
    s_mov_b32 s65, 98304
    buffer_load_dwordx4 v[72:75], v11, s[20:23], s65 offen
    s_mov_b32 s92, 0
    s_mul_i32 s93, s60, 65536
    s_add_u32 s92, s92, s93
    s_mul_i32 s93, s5, 16384
    s_add_u32 s92, s92, s93
    s_add_u32 s52, s66, s92
    s_addc_u32 s53, s67, 0
    s_mov_b32 s92, 0
    s_mul_i32 s93, s4, 655360
    s_add_u32 s92, s92, s93
    s_mul_i32 s93, s5, 163840
    s_add_u32 s92, s92, s93
    s_mul_i32 s93, s3, 256
    s_add_u32 s92, s92, s93
    s_add_u32 s42, s80, s92
    s_addc_u32 s43, s81, 0
    s_mov_b32 s92, 0
    s_mul_i32 s93, s4, 524288
    s_add_u32 s92, s92, s93
    s_mul_i32 s93, s5, 131072
    s_add_u32 s92, s92, s93
    s_mul_i32 s93, s3, 256
    s_add_u32 s92, s92, s93
    s_add_u32 s46, s72, s92
    s_addc_u32 s47, s73, 0
    s_mov_b32 s92, 0
    s_mul_i32 s93, s3, 163840
    s_add_u32 s92, s92, s93
    s_mul_i32 s93, s5, 40960
    s_add_u32 s92, s92, s93
    s_mul_i32 s93, s4, 160
    s_add_u32 s92, s92, s93
    s_add_u32 s48, s74, s92
    s_addc_u32 s49, s75, 0
    s_mov_b32 s92, 0
    s_mul_i32 s93, s3, 163840
    s_add_u32 s92, s92, s93
    s_mul_i32 s93, s5, 40960
    s_add_u32 s92, s92, s93
    s_mul_i32 s93, s4, 160
    s_add_u32 s92, s92, s93
    s_add_u32 s50, s82, s92
    s_addc_u32 s51, s83, 0
    s_mov_b32 s92, 0
    s_mul_i32 s93, s3, 2097152
    s_add_u32 s92, s92, s93
    s_mul_i32 s93, s4, 262144
    s_add_u32 s92, s92, s93
    s_mul_i32 s93, s5, 65536
    s_add_u32 s92, s92, s93
    s_add_u32 s12, s76, s92
    s_addc_u32 s13, s77, 0
    s_mov_b32 s92, 0
    s_mul_i32 s93, s3, 2097152
    s_add_u32 s92, s92, s93
    s_mul_i32 s93, s4, 262144
    s_add_u32 s92, s92, s93
    s_mul_i32 s93, s5, 65536
    s_add_u32 s92, s92, s93
    s_add_u32 s16, s78, s92
    s_addc_u32 s17, s79, 0
    s_mov_b32 s14, 65536
    s_mov_b32 s15, 0x20000
    s_mov_b32 s18, 65536
    s_mov_b32 s19, 0x20000
    s_mov_b32 s54, s84
    s_mov_b32 s55, s85
    s_mov_b32 s24, s52
    s_mov_b32 s25, s53
    s_mov_b32 s26, 0x4000
    s_mov_b32 s27, 0x20000
    s_mov_b32 s88, 0
    s_mov_b32 s89, 0
    s_mov_b32 s84, 0x001f001f
    s_mov_b32 s85, 0x001f001f
    s_mov_b32 s36, 0x7060500
    s_mov_b32 s37, 0x7060501
    s_mov_b32 s38, 0x7060502
    s_mov_b32 s39, 0x7060503
    s_mov_b32 s76, 0xf000f
    s_mov_b32 s77, 0xf000f
    s_mov_b32 s78, 0xf000f0
    s_mov_b32 s79, 0xf000f0
    s_mov_b32 s80, 0xf000f00
    s_mov_b32 s81, 0xf000f00
    s_mov_b32 s82, 0xf000f000
    s_mov_b32 s83, 0xf000f000
    s_lshl_b32 s92, s98, 5
    s_add_u32 s92, s92, s99
    s_lshl_b32 s92, s92, 2
    s_add_u32 s92, s92, s5
    s_lshl_b32 s92, s92, 12
    s_add_u32 s56, s92, 3145728
    s_getpc_b64 s[28:29]
L_pc0:
    s_add_u32 s28, s28, L_stream-L_pc0
    s_addc_u32 s29, s29, 0
    s_mov_b32 s7, 1
    s_mov_b32 s63, 0
    s_mov_b32 s58, 0x1c0000
    s_getreg_b32 s101, hwreg(HW_REG_XCC_ID)
    s_and_b32 s101, s101, 0xf
    s_add_u32 s101, s101, 1
    s_lshl_b32 s101, s101, 8
    s_getpc_b64 s[70:71]
L_pc1:
    s_add_u32 s70, s70, L_dw-L_pc1
    s_addc_u32 s71, s71, 0
    s_cmp_eq_u32 s7, 0
    s_cbranch_scc1 dwn_4
    s_mov_b32 s74, 4
    s_mov_b32 s95, 20
    s_mov_b32 s0, 24
    s_swappc_b64 s[72:73], s[70:71]
    s_branch dwj_5
dwn_4:
    s_waitcnt vmcnt(4)
dwj_5:
    v_readfirstlane_b32 s97, v5
    s_nop 0
    s_mul_i32 s97, s97, 0x9E3779B1
    s_add_u32 s97, s97, 0x7F4A7C15
    v_mov_b32 v5, s97
    s_and_b32 s32, s97, 0xff
    s_bfe_u32 s33, s97, 0x80008
    s_bfe_u32 s34, s97, 0x80010
    s_lshr_b32 s35, s97, 24
    v_lshlrev_b32 v6, 16, v6
    s_cmp_lg_u32 s5, 0
    s_cbranch_scc1 xp_6
    v_mov_b32 v16, s101
    v_mov_b32 v17, s101
    v_mov_b32 v18, s101
    v_mov_b32 v19, s101
    v_perm_b32 v16, v16, v5, s36
    v_perm_b32 v17, v17, v5, s37
    v_perm_b32 v18, v18, v5, s38
    v_perm_b32 v19, v19, v5, s39
    s_lshl_b32 s92, s98, 9
    s_lshl_b32 s93, s99, 4
    s_add_u32 s92, s92, s93
    s_add_u32 s92, s92, 4096
    v_mov_b32 v20, 0
    s_mov_b64 exec, 1
    buffer_store_dwordx4 v[16:19], v20, s[8:11], s92 offen sc1
    s_mov_b64 exec, -1
xp_6:
    v_lshrrev_b32 v37, 4, v0
    v_and_b32 v38, 1, v37
    v_lshlrev_b32 v38, 4, v38
    v_lshrrev_b32 v39, 1, v37
    v_add_u32 v38, v38, v39
    v_lshlrev_b32 v38, 4, v38
    v_cmp_gt_u32 vcc, 32, v37
    v_mov_b32 v39, 512
    s_nop 0
    v_cndmask_b32 v37, v39, v38, vcc
    s_lshl_b32 s69, s3, 3
    s_add_u32 s69, s69, s4
    s_lshl_b32 s69, s69, 11
    s_add_u32 s69, s69, 1048576
L_layer:
    s_cmp_eq_u32 s6, 0
    s_cbranch_scc1 q2w_7
    s_bitcmp1_b32 s6, 0
    s_cbranch_scc1 nouk_8
    s_mov_b32 s20, s44
    s_mov_b32 s21, s45
    s_mov_b32 s22, 0x1e100
    s_mov_b32 s23, 0x20000
    v_lshrrev_b32 v11, 8, v8
    v_lshlrev_b32 v11, 13, v11
    v_and_b32 v12, s64, v8
    v_or_b32 v11, v11, v12
    s_mov_b32 s65, 0
    buffer_load_dwordx4 v[60:63], v11, s[20:23], s65 offen
    s_mov_b32 s65, 32768
    buffer_load_dwordx4 v[64:67], v11, s[20:23], s65 offen
    s_mov_b32 s65, 65536
    buffer_load_dwordx4 v[68:71], v11, s[20:23], s65 offen
    s_mov_b32 s65, 98304
    buffer_load_dwordx4 v[72:75], v11, s[20:23], s65 offen
    s_branch vtj_9
nouk_8:
    s_mov_b32 s67, 57344
    buffer_load_dwordx4 v[60:63], v9, s[16:19], s67 offen offset:0
    buffer_load_dwordx4 v[64:67], v9, s[16:19], s67 offen offset:2048
    buffer_load_dwordx4 v[68:71], v9, s[16:19], s67 offen offset:512
    buffer_load_dwordx4 v[72:75], v9, s[16:19], s67 offen offset:2560
vtj_9:
q2w_7:
    v_cvt_pk_bf16_f32 v14, v6, v6
    v_and_b32 v38, 0xffff0000, v14
    v_mul_f32 v39, v38, v38
    v_and_b32_dpp v24, v14, v1 row_newbcast:0 row_mask:0xf bank_mask:0xf
    v_and_b32_dpp v25, v14, v2 row_newbcast:0 row_mask:0xf bank_mask:0xf
    v_and_b32_dpp v26, v14, v3 row_newbcast:0 row_mask:0xf bank_mask:0xf
    v_and_b32_dpp v27, v14, v4 row_newbcast:0 row_mask:0xf bank_mask:0xf
    v_and_b32_dpp v28, v14, v1 row_newbcast:1 row_mask:0xf bank_mask:0xf
    v_and_b32_dpp v29, v14, v2 row_newbcast:1 row_mask:0xf bank_mask:0xf
    v_and_b32_dpp v30, v14, v3 row_newbcast:1 row_mask:0xf bank_mask:0xf
    v_and_b32_dpp v31, v14, v4 row_newbcast:1 row_mask:0xf bank_mask:0xf
    v_mfma_f32_16x16x32_bf16 v[16:19], v[24:27], v[76:79], 0
    v_and_b32_dpp v24, v14, v1 row_newbcast:2 row_mask:0xf bank_mask:0xf
    v_and_b32_dpp v25, v14, v2 row_newbcast:2 row_mask:0xf bank_mask:0xf
    v_and_b32_dpp v26, v14, v3 row_newbcast:2 row_mask:0xf bank_mask:0xf
    v_and_b32_dpp v27, v14, v4 row_newbcast:2 row_mask:0xf bank_mask:0xf
    v_mfma_f32_16x16x32_bf16 v[16:19], v[28:31], v[80:83], v[16:19]
    v_and_b32_dpp v28, v14, v1 row_newbcast:3 row_mask:0xf bank_mask:0xf
    v_and_b32_dpp v29, v14, v2 row_newbcast:3 row_mask:0xf bank_mask:0xf
    v_and_b32_dpp v30, v14, v3 row_newbcast:3 row_mask:0xf bank_mask:0xf
    v_and_b32_dpp v31, v14, v4 row_newbcast:3 row_mask:0xf bank_mask:0xf
    v_mfma_f32_16x16x32_bf16 v[16:19], v[24:27], v[84:87], v[16:19]
    v_and_b32_dpp v24, v14, v1 row_newbcast:4 row_mask:0xf bank_mask:0xf
    v_and_b32_dpp v25, v14, v2 row_newbcast:4 row_mask:0xf bank_mask:0xf
    v_and_b32_dpp v26, v14, v3 row_newbcast:4 row_mask:0xf bank_mask:0xf
    v_and_b32_dpp v27, v14, v4 row_newbcast:4 row_mask:0xf bank_mask:0xf
    v_mfma_f32_16x16x32_bf16 v[16:19], v[28:31], v[88:91], v[16:19]
    s_nop 0
    v_mfma_f32_16x16x32_bf16 v[16:19], v[24:27], v[92:95], v[16:19]
    v_add_f32_dpp v38, v38, v38 quad_perm:[1,0,3,2] row_mask:0xf bank_mask:0xf
    v_add_f32_dpp v39, v39, v39 quad_perm:[1,0,3,2] row_mask:0xf bank_mask:0xf
    s_nop 0
    v_add_f32_dpp v38, v38, v38 quad_perm:[2,3,0,1] row_mask:0xf bank_mask:0xf
    v_add_f32_dpp v39, v39, v39 quad_perm:[2,3,0,1] row_mask:0xf bank_mask:0xf
    s_nop 0
    v_add_f32_dpp v38, v38, v38 row_half_mirror row_mask:0xf bank_mask:0xf
    v_add_f32_dpp v39, v39, v39 row_half_mirror row_mask:0xf bank_mask:0xf
    s_nop 0
    v_add_f32_dpp v38, v38, v38 row_mirror row_mask:0xf bank_mask:0xf
    v_add_f32_dpp v39, v39, v39 row_mirror row_mask:0xf bank_mask:0xf
    s_nop 0
    v_add_f32_dpp v38, v38, v38 row_bcast:15 row_mask:0xa bank_mask:0xf
    v_add_f32_dpp v39, v39, v39 row_bcast:15 row_mask:0xa bank_mask:0xf
    s_nop 0
    v_add_f32_dpp v38, v38, v38 row_bcast:31 row_mask:0xc bank_mask:0xf
    v_add_f32_dpp v39, v39, v39 row_bcast:31 row_mask:0xc bank_mask:0xf
    s_mov_b32 exec_hi, 0
    ds_write_b128 v10, v[16:19]
    s_mov_b32 exec_lo, 0
    s_mov_b32 exec_hi, 0x80000000
    ds_write_b64 v10, v[38:39]
    s_mov_b64 exec, -1
    s_cmp_ge_u32 s6, 2
    s_cbranch_scc1 nou_10
    v_and_b32 v32, 0x3f803f80, v1
    v_and_b32 v33, 0x3f803f80, v2
    v_and_b32 v34, 0x3f803f80, v3
    v_and_b32 v35, 0x3f803f80, v4
    s_nop 1
    v_mfma_f32_16x16x32_bf16 v[20:23], v[32:35], v[76:79], 0
    v_mfma_f32_16x16x32_bf16 v[20:23], v[32:35], v[80:83], v[20:23]
    v_mfma_f32_16x16x32_bf16 v[20:23], v[32:35], v[84:87], v[20:23]
    v_mfma_f32_16x16x32_bf16 v[20:23], v[32:35], v[88:91], v[20:23]
    v_mfma_f32_16x16x32_bf16 v[20:23], v[32:35], v[92:95], v[20:23]
    s_mov_b32 exec_hi, 1
    s_nop 6
    ds_write_b128 v10, v[20:23] offset:528
    s_mov_b32 exec_hi, -1
nou_10:
    s_waitcnt lgkmcnt(0)
    s_barrier
    s_cmp_lg_u32 s5, 0
    s_cbranch_scc1 qfin_11
    v_add_u32 v11, 156160, v0
    ds_read_b128 v[16:19], v11 offset:0
    ds_read_b128 v[20:23], v11 offset:1056
    ds_read_b128 v[24:27], v11 offset:2112
    ds_read_b128 v[28:31], v11 offset:3168
    s_waitcnt lgkmcnt(0)
    v_add_f32 v16, v16, v20
    v_add_f32 v24, v24, v28
    v_add_f32 v17, v17, v21
    v_add_f32 v25, v25, v29
    v_add_f32 v18, v18, v22
    v_add_f32 v26, v26, v30
    v_add_f32 v19, v19, v23
    v_add_f32 v27, v27, v31
    v_add_f32 v16, v16, v24
    v_add_f32 v17, v17, v25
    v_add_f32 v18, v18, v26
    v_add_f32 v19, v19, v27
    v_perm_b32 v16, v16, v5, s36
    v_perm_b32 v17, v17, v5, s37
    v_perm_b32 v18, v18, v5, s38
    v_perm_b32 v19, v19, v5, s39
    s_mov_b32 exec_hi, 1
    s_cmp_eq_u32 s89, 0
    s_cbranch_scc1 ls_12
    buffer_store_dwordx4 v[16:19], v37, s[8:11], s69 offen
    s_branch ls_13
ls_12:
    buffer_store_dwordx4 v[16:19], v37, s[8:11], s69 offen sc1
ls_13:
    s_mov_b32 exec_hi, -1
    s_cmp_ge_u32 s6, 2
    s_cbranch_scc1 qfin_11
    v_add_u32 v11, 156160, v0
    ds_read_b128 v[40:43], v11 offset:528
    ds_read_b128 v[44:47], v11 offset:1584
    ds_read_b128 v[48:51], v11 offset:2640
    ds_read_b128 v[52:55], v11 offset:3696
    s_add_u32 s69, s69, 1024
    s_waitcnt lgkmcnt(0)
    v_add_f32 v40, v40, v44
    v_add_f32 v48, v48, v52
    v_add_f32 v41, v41, v45
    v_add_f32 v49, v49, v53
    v_add_f32 v42, v42, v46
    v_add_f32 v50, v50, v54
    v_add_f32 v43, v43, v47
    v_add_f32 v51, v51, v55
    v_add_f32 v40, v40, v48
    v_add_f32 v41, v41, v49
    v_add_f32 v42, v42, v50
    v_add_f32 v43, v43, v51
    v_perm_b32 v40, v40, v5, s36
    v_perm_b32 v41, v41, v5, s37
    v_perm_b32 v42, v42, v5, s38
    v_perm_b32 v43, v43, v5, s39
    s_mov_b32 exec_hi, 0
    s_cmp_eq_u32 s89, 0
    s_cbranch_scc1 ls_14
    buffer_store_dwordx4 v[40:43], v37, s[8:11], s69 offen
    s_branch ls_15
ls_14:
    buffer_store_dwordx4 v[40:43], v37, s[8:11], s69 offen sc1
ls_15:
    s_mov_b32 exec_hi, -1
qfin_11:
    v_lshrrev_b32 v14, 8, v8
    v_lshlrev_b32 v14, 11, v14
    v_and_b32 v15, s64, v8
    v_or_b32 v14, v14, v15
    v_lshlrev_b32 v56, 1, v15
    v_lshrrev_b32 v15, 4, v0
    v_and_b32 v15, 7, v15
    v_lshlrev_b32 v15, 11, v15
    s_lshl_b32 s65, s3, 14
    s_add_u32 s65, s65, 1048576
    s_add_u32 s66, s65, 8192
    s_and_b32 s67, s6, 1
    s_lshl_b32 s67, s67, 9
    s_add_u32 s67, s67, 160384
    v_add_u32 v56, s67, v56
    s_cmp_ge_u32 s6, 2
    s_cbranch_scc1 qlate_16
    s_cmp_eq_u32 s6, 1
    s_cbranch_scc1 qone_18
    v_and_b32 v57, 0x1f0, v0
    s_lshl_b32 s68, s98, 9
    s_add_u32 s68, s68, 4096
    s_mov_b32 s62, 0
    s_cmp_eq_u32 s7, 0
    s_cbranch_scc1 dwn_24
    s_mov_b32 s74, 0
    s_mov_b32 s95, 20
    s_mov_b32 s0, 36
    s_swappc_b64 s[72:73], s[70:71]
    s_branch dwj_25
dwn_24:
    s_waitcnt vmcnt(0)
dwj_25:
    s_barrier
poll_20:
    buffer_load_dwordx4 v[16:19], v14, s[8:11], s65 offen offset:0 sc1
    buffer_load_dwordx4 v[20:23], v14, s[8:11], s65 offen offset:256 sc1
    buffer_load_dwordx4 v[24:27], v14, s[8:11], s66 offen offset:0 sc1
    buffer_load_dwordx4 v[28:31], v14, s[8:11], s66 offen offset:256 sc1
    buffer_load_dwordx4 v[32:35], v15, s[8:11], s65 offen offset:512 sc1
    buffer_load_dwordx4 v[36:39], v14, s[8:11], s65 offen offset:1024 sc1
    buffer_load_dwordx4 v[40:43], v14, s[8:11], s65 offen offset:1280 sc1
    buffer_load_dwordx4 v[44:47], v14, s[8:11], s66 offen offset:1024 sc1
    buffer_load_dwordx4 v[48:51], v14, s[8:11], s66 offen offset:1280 sc1
    buffer_load_dwordx4 v[52:55], v57, s[8:11], s68 offen sc1
    s_cmp_eq_u32 s7, 0
    s_cbranch_scc1 dwn_26
    s_mov_b32 s74, 0
    s_mov_b32 s95, 30
    s_mov_b32 s0, 36
    s_swappc_b64 s[72:73], s[70:71]
    s_branch dwj_27
dwn_26:
    s_waitcnt vmcnt(0)
dwj_27:
pj_22:
    v_xor_b32 v16, s32, v16
    v_xor_b32 v17, s33, v17
    v_xor_b32 v18, s34, v18
    v_xor_b32 v19, s35, v19
    v_xor_b32 v20, s32, v20
    v_xor_b32 v21, s33, v21
    v_xor_b32 v22, s34, v22
    v_xor_b32 v23, s35, v23
    v_xor_b32 v24, s32, v24
    v_xor_b32 v25, s33, v25
    v_xor_b32 v26, s34, v26
    v_xor_b32 v27, s35, v27
    v_xor_b32 v28, s32, v28
    v_xor_b32 v29, s33, v29
    v_xor_b32 v30, s34, v30
    v_xor_b32 v31, s35, v31
    v_xor_b32 v32, s32, v32
    v_xor_b32 v33, s33, v33
    v_xor_b32 v34, s34, v34
    v_xor_b32 v35, s35, v35
    v_xor_b32 v36, s32, v36
    v_xor_b32 v37, s33, v37
    v_xor_b32 v38, s34, v38
    v_xor_b32 v39, s35, v39
    v_xor_b32 v40, s32, v40
    v_xor_b32 v41, s33, v41
    v_xor_b32 v42, s34, v42
    v_xor_b32 v43, s35, v43
    v_xor_b32 v44, s32, v44
    v_xor_b32 v45, s33, v45
    v_xor_b32 v46, s34, v46
    v_xor_b32 v47, s35, v47
    v_xor_b32 v48, s32, v48
    v_xor_b32 v49, s33, v49
    v_xor_b32 v50, s34, v50
    v_xor_b32 v51, s35, v51
    v_xor_b32 v52, s32, v52
    v_xor_b32 v53, s33, v53
    v_xor_b32 v54, s34, v54
    v_xor_b32 v55, s35, v55
    v_or3_b32 v11, v16, v17, v18
    v_or3_b32 v12, v19, v20, v21
    v_or3_b32 v11, v11, v22, v23
    v_or3_b32 v12, v12, v24, v25
    v_or3_b32 v11, v11, v26, v27
    v_or3_b32 v12, v12, v28, v29
    v_or3_b32 v11, v11, v30, v31
    v_or3_b32 v12, v12, v32, v33
    v_or3_b32 v11, v11, v34, v35
    v_or3_b32 v12, v12, v36, v37
    v_or3_b32 v11, v11, v38, v39
    v_or3_b32 v12, v12, v40, v41
    v_or3_b32 v11, v11, v42, v43
    v_or3_b32 v12, v12, v44, v45
    v_or3_b32 v11, v11, v46, v47
    v_or3_b32 v12, v12, v48, v49
    v_or3_b32 v11, v11, v50, v51
    v_or3_b32 v12, v12, v52, v53
    v_or3_b32 v11, v11, v54, v55
    v_or_b32 v11, v11, v12
    v_and_b32 v11, s64, v11
    v_cmp_ne_u32 vcc, 0, v11
    s_cbranch_vccz pdone_23
    s_add_u32 s62, s62, 1
    s_cmp_lt_u32 s62, 65536
    s_cbranch_scc1 poll_20
    s_mov_b32 s88, 1
pdone_23:
    v_cmp_ne_u32 vcc, s101, v52
    s_nop 0
    s_cmp_eq_u64 vcc, 0
    s_cselect_b32 s89, 1, 0
    s_branch qu_19
qone_18:
    s_mov_b32 s62, 0
    s_cmp_eq_u32 s7, 0
    s_cbranch_scc1 dwn_32
    s_mov_b32 s74, 0
    s_mov_b32 s95, 20
    s_mov_b32 s0, 130
    s_swappc_b64 s[72:73], s[70:71]
    s_branch dwj_33
dwn_32:
    s_waitcnt vmcnt(0)
dwj_33:
    s_barrier
poll_28:
    buffer_load_dwordx4 v[16:19], v14, s[8:11], s65 offen offset:0 sc1
    buffer_load_dwordx4 v[20:23], v14, s[8:11], s65 offen offset:256 sc1
    buffer_load_dwordx4 v[24:27], v14, s[8:11], s66 offen offset:0 sc1
    buffer_load_dwordx4 v[28:31], v14, s[8:11], s66 offen offset:256 sc1
    buffer_load_dwordx4 v[32:35], v15, s[8:11], s65 offen offset:512 sc1
    buffer_load_dwordx4 v[36:39], v14, s[8:11], s65 offen offset:1024 sc1
    buffer_load_dwordx4 v[40:43], v14, s[8:11], s65 offen offset:1280 sc1
    buffer_load_dwordx4 v[44:47], v14, s[8:11], s66 offen offset:1024 sc1
    buffer_load_dwordx4 v[48:51], v14, s[8:11], s66 offen offset:1280 sc1
    s_cmp_eq_u32 s7, 0
    s_cbranch_scc1 dwn_34
    s_mov_b32 s74, 0
    s_mov_b32 s95, 29
    s_mov_b32 s0, 130
    s_swappc_b64 s[72:73], s[70:71]
    s_branch dwj_35
dwn_34:
    s_waitcnt vmcnt(0)
dwj_35:
pj_30:
    v_xor_b32 v16, s32, v16
    v_xor_b32 v17, s33, v17
    v_xor_b32 v18, s34, v18
    v_xor_b32 v19, s35, v19
    v_xor_b32 v20, s32, v20
    v_xor_b32 v21, s33, v21
    v_xor_b32 v22, s34, v22
    v_xor_b32 v23, s35, v23
    v_xor_b32 v24, s32, v24
    v_xor_b32 v25, s33, v25
    v_xor_b32 v26, s34, v26
    v_xor_b32 v27, s35, v27
    v_xor_b32 v28, s32, v28
    v_xor_b32 v29, s33, v29
    v_xor_b32 v30, s34, v30
    v_xor_b32 v31, s35, v31
    v_xor_b32 v32, s32, v32
    v_xor_b32 v33, s33, v33
    v_xor_b32 v34, s34, v34
    v_xor_b32 v35, s35, v35
    v_xor_b32 v36, s32, v36
    v_xor_b32 v37, s33, v37
    v_xor_b32 v38, s34, v38
    v_xor_b32 v39, s35, v39
    v_xor_b32 v40, s32, v40
    v_xor_b32 v41, s33, v41
    v_xor_b32 v42, s34, v42
    v_xor_b32 v43, s35, v43
    v_xor_b32 v44, s32, v44
    v_xor_b32 v45, s33, v45
    v_xor_b32 v46, s34, v46
    v_xor_b32 v47, s35, v47
    v_xor_b32 v48, s32, v48
    v_xor_b32 v49, s33, v49
    v_xor_b32 v50, s34, v50
    v_xor_b32 v51, s35, v51
    v_or3_b32 v11, v16, v17, v18
    v_or3_b32 v12, v19, v20, v21
    v_or3_b32 v11, v11, v22, v23
    v_or3_b32 v12, v12, v24, v25
    v_or3_b32 v11, v11, v26, v27
    v_or3_b32 v12, v12, v28, v29
    v_or3_b32 v11, v11, v30, v31
    v_or3_b32 v12, v12, v32, v33
    v_or3_b32 v11, v11, v34, v35
    v_or3_b32 v12, v12, v36, v37
    v_or3_b32 v11, v11, v38, v39
    v_or3_b32 v12, v12, v40, v41
    v_or3_b32 v11, v11, v42, v43
    v_or3_b32 v12, v12, v44, v45
    v_or3_b32 v11, v11, v46, v47
    v_or3_b32 v12, v12, v48, v49
    v_or3_b32 v11, v11, v50, v51
    v_or_b32 v11, v11, v12
    v_and_b32 v11, s64, v11
    v_cmp_ne_u32 vcc, 0, v11
    s_cbranch_vccz pdone_31
    s_add_u32 s62, s62, 1
    s_cmp_lt_u32 s62, 65536
    s_cbranch_scc1 poll_28
    s_mov_b32 s88, 1
pdone_31:
qu_19:
    v_add_f32 v36, v36, v44
    v_add_f32 v37, v37, v45
    v_add_f32 v38, v38, v46
    v_add_f32 v39, v39, v47
    v_add_f32 v40, v40, v48
    v_add_f32 v41, v41, v49
    v_add_f32 v42, v42, v50
    v_add_f32 v43, v43, v51
    v_add_f32_dpp v36, v36, v36 row_ror:4 row_mask:0xf bank_mask:0xf
    v_add_f32_dpp v37, v37, v37 row_ror:4 row_mask:0xf bank_mask:0xf
    v_add_f32_dpp v38, v38, v38 row_ror:4 row_mask:0xf bank_mask:0xf
    v_add_f32_dpp v39, v39, v39 row_ror:4 row_mask:0xf bank_mask:0xf
    v_add_f32_dpp v40, v40, v40 row_ror:4 row_mask:0xf bank_mask:0xf
    v_add_f32_dpp v41, v41, v41 row_ror:4 row_mask:0xf bank_mask:0xf
    v_add_f32_dpp v42, v42, v42 row_ror:4 row_mask:0xf bank_mask:0xf
    v_add_f32_dpp v43, v43, v43 row_ror:4 row_mask:0xf bank_mask:0xf
    v_add_f32_dpp v36, v36, v36 row_ror:8 row_mask:0xf bank_mask:0xf
    v_add_f32_dpp v37, v37, v37 row_ror:8 row_mask:0xf bank_mask:0xf
    v_add_f32_dpp v38, v38, v38 row_ror:8 row_mask:0xf bank_mask:0xf
    v_add_f32_dpp v39, v39, v39 row_ror:8 row_mask:0xf bank_mask:0xf
    v_add_f32_dpp v40, v40, v40 row_ror:8 row_mask:0xf bank_mask:0xf
    v_add_f32_dpp v41, v41, v41 row_ror:8 row_mask:0xf bank_mask:0xf
    v_add_f32_dpp v42, v42, v42 row_ror:8 row_mask:0xf bank_mask:0xf
    v_add_f32_dpp v43, v43, v43 row_ror:8 row_mask:0xf bank_mask:0xf
    s_cmp_lg_u32 s5, 0
    s_cbranch_scc1 uw_36
    s_mov_b32 exec_lo, 0xf000f
    s_mov_b32 exec_hi, 0xf000f
    ds_write_b128 v56, v[36:39]
    ds_write_b128 v56, v[40:43] offset:16
    s_mov_b64 exec, -1
uw_36:
    s_branch qj_17
qlate_16:
    ds_read_b128 v[36:39], v56
    ds_read_b128 v[40:43], v56 offset:16
    s_mov_b32 s62, 0
    s_sleep 2
poll_37:
    buffer_load_dwordx4 v[16:19], v14, s[8:11], s65 offen offset:0 sc1
    buffer_load_dwordx4 v[20:23], v14, s[8:11], s65 offen offset:256 sc1
    buffer_load_dwordx4 v[24:27], v14, s[8:11], s66 offen offset:0 sc1
    buffer_load_dwordx4 v[28:31], v14, s[8:11], s66 offen offset:256 sc1
    buffer_load_dwordx4 v[32:35], v15, s[8:11], s65 offen offset:512 sc1
    s_cmp_eq_u32 s7, 0
    s_cbranch_scc1 dwn_41
    s_mov_b32 s74, 0
    s_mov_b32 s95, 25
    s_mov_b32 s0, 999
    s_swappc_b64 s[72:73], s[70:71]
    s_branch dwj_42
dwn_41:
    s_waitcnt vmcnt(0)
dwj_42:
pj_39:
    v_xor_b32 v16, s32, v16
    v_xor_b32 v17, s33, v17
    v_xor_b32 v18, s34, v18
    v_xor_b32 v19, s35, v19
    v_xor_b32 v20, s32, v20
    v_xor_b32 v21, s33, v21
    v_xor_b32 v22, s34, v22
    v_xor_b32 v23, s35, v23
    v_xor_b32 v24, s32, v24
    v_xor_b32 v25, s33, v25
    v_xor_b32 v26, s34, v26
    v_xor_b32 v27, s35, v27
    v_xor_b32 v28, s32, v28
    v_xor_b32 v29, s33, v29
    v_xor_b32 v30, s34, v30
    v_xor_b32 v31, s35, v31
    v_xor_b32 v32, s32, v32
    v_xor_b32 v33, s33, v33
    v_xor_b32 v34, s34, v34
    v_xor_b32 v35, s35, v35
    v_or3_b32 v11, v16, v17, v18
    v_or3_b32 v12, v19, v20, v21
    v_or3_b32 v11, v11, v22, v23
    v_or3_b32 v12, v12, v24, v25
    v_or3_b32 v11, v11, v26, v27
    v_or3_b32 v12, v12, v28, v29
    v_or3_b32 v11, v11, v30, v31
    v_or3_b32 v12, v12, v32, v33
    v_or3_b32 v11, v11, v34, v35
    v_or_b32 v11, v11, v12
    v_and_b32 v11, s64, v11
    v_cmp_ne_u32 vcc, 0, v11
    s_cbranch_vccz pdone_40
    s_add_u32 s62, s62, 1
    s_cmp_lt_u32 s62, 65536
    s_cbranch_scc1 poll_37
    s_mov_b32 s88, 1
pdone_40:
    s_waitcnt lgkmcnt(0)
qj_17:
    v_add_f32_dpp v32, v32, v32 quad_perm:[1,0,3,2] row_mask:0xf bank_mask:0xf
    v_add_f32_dpp v33, v33, v33 quad_perm:[1,0,3,2] row_mask:0xf bank_mask:0xf
    v_add_f32 v16, v16, v24
    v_add_f32 v17, v17, v25
    v_add_f32 v18, v18, v26
    v_add_f32_dpp v32, v32, v32 quad_perm:[2,3,0,1] row_mask:0xf bank_mask:0xf
    v_add_f32_dpp v33, v33, v33 quad_perm:[2,3,0,1] row_mask:0xf bank_mask:0xf
    v_add_f32 v19, v19, v27
    v_add_f32 v20, v20, v28
    v_add_f32 v21, v21, v29
    v_add_f32_dpp v32, v32, v32 row_half_mirror row_mask:0xf bank_mask:0xf
    v_add_f32_dpp v33, v33, v33 row_half_mirror row_mask:0xf bank_mask:0xf
    v_add_f32 v22, v22, v30
    v_add_f32 v23, v23, v31
    v_mul_f32 v32, 0x3acccccd, v32
    v_mul_f32 v33, 0x3acccccd, v33
    v_add_f32_dpp v16, v16, v16 row_ror:4 row_mask:0xf bank_mask:0xf
    v_add_f32_dpp v17, v17, v17 row_ror:4 row_mask:0xf bank_mask:0xf
    v_add_f32_dpp v18, v18, v18 row_ror:4 row_mask:0xf bank_mask:0xf
    v_add_f32_dpp v19, v19, v19 row_ror:4 row_mask:0xf bank_mask:0xf
    v_fma_f32 v33, -v32, v32, v33
    v_add_f32_dpp v20, v20, v20 row_ror:4 row_mask:0xf bank_mask:0xf
    v_add_f32_dpp v21, v21, v21 row_ror:4 row_mask:0xf bank_mask:0xf
    v_add_f32_dpp v22, v22, v22 row_ror:4 row_mask:0xf bank_mask:0xf
    v_add_f32_dpp v23, v23, v23 row_ror:4 row_mask:0xf bank_mask:0xf
    v_add_f32 v33, 0x3727c5ac, v33
    v_add_f32_dpp v16, v16, v16 row_ror:8 row_mask:0xf bank_mask:0xf
    v_add_f32_dpp v17, v17, v17 row_ror:8 row_mask:0xf bank_mask:0xf
    v_add_f32_dpp v18, v18, v18 row_ror:8 row_mask:0xf bank_mask:0xf
    v_add_f32_dpp v19, v19, v19 row_ror:8 row_mask:0xf bank_mask:0xf
    v_rsq_f32 v33, v33
    v_add_f32_dpp v20, v20, v20 row_ror:8 row_mask:0xf bank_mask:0xf
    v_add_f32_dpp v21, v21, v21 row_ror:8 row_mask:0xf bank_mask:0xf
    v_add_f32_dpp v22, v22, v22 row_ror:8 row_mask:0xf bank_mask:0xf
    v_add_f32_dpp v23, v23, v23 row_ror:8 row_mask:0xf bank_mask:0xf
    v_mul_f32 v33, 0x3e0293ee, v33
    v_fma_f32 v16, -v32, v36, v16
    v_fma_f32 v17, -v32, v37, v17
    v_fma_f32 v18, -v32, v38, v18
    v_fma_f32 v19, -v32, v39, v19
    v_fma_f32 v20, -v32, v40, v20
    v_fma_f32 v21, -v32, v41, v21
    v_fma_f32 v22, -v32, v42, v22
    v_fma_f32 v23, -v32, v43, v23
    v_readfirstlane_b32 s100, v33
    v_cvt_pk_bf16_f32 v24, v16, v17
    v_cvt_pk_bf16_f32 v25, v18, v19
    v_cvt_pk_bf16_f32 v26, v20, v21
    v_cvt_pk_bf16_f32 v27, v22, v23
    v_cndmask_b32 v44, 0, v24, s[76:77]
    v_cndmask_b32 v45, 0, v25, s[76:77]
    v_cndmask_b32 v46, 0, v26, s[76:77]
    v_cndmask_b32 v47, 0, v27, s[76:77]
    v_cndmask_b32 v48, 0, v24, s[78:79]
    v_cndmask_b32 v49, 0, v25, s[78:79]
    v_cndmask_b32 v50, 0, v26, s[78:79]
    v_cndmask_b32 v51, 0, v27, s[78:79]
    v_cndmask_b32 v52, 0, v24, s[80:81]
    v_cndmask_b32 v53, 0, v25, s[80:81]
    v_cndmask_b32 v54, 0, v26, s[80:81]
    v_cndmask_b32 v55, 0, v27, s[80:81]
    v_cndmask_b32 v56, 0, v24, s[82:83]
    v_cndmask_b32 v57, 0, v25, s[82:83]
    v_cndmask_b32 v58, 0, v26, s[82:83]
    v_cndmask_b32 v59, 0, v27, s[82:83]
    s_bitcmp1_b32 s6, 0
    s_cbranch_scc1 L_bmid
    v_mfma_f32_16x16x32_bf16 v[16:19], v[44:47], v[60:63], 0
    v_mfma_f32_16x16x32_bf16 v[16:19], v[48:51], v[64:67], v[16:19]
    v_mfma_f32_16x16x32_bf16 v[16:19], v[52:55], v[68:71], v[16:19]
    v_mfma_f32_16x16x32_bf16 v[16:19], v[56:59], v[72:75], v[16:19]
    v_lshrrev_b32 v14, 8, v0
    v_lshlrev_b32 v14, 4, v14
    s_lshl_b32 s65, s3, 11
    s_lshl_b32 s66, s4, 8
    s_add_u32 s65, s65, s66
    s_lshl_b32 s66, s5, 6
    s_add_u32 s65, s65, s66
    s_add_u32 s65, s65, 2097152
    v_mov_b32_dpp v20, v16 quad_perm:[0,0,0,0] row_mask:0xf bank_mask:0xf
    v_mov_b32_dpp v21, v18 quad_perm:[2,2,2,2] row_mask:0xf bank_mask:0xf
    s_nop 0
    v_add_f32_dpp v20, v17, v20 quad_perm:[1,1,1,1] row_mask:0xf bank_mask:0xf
    v_add_f32_dpp v21, v19, v21 quad_perm:[3,3,3,3] row_mask:0xf bank_mask:0xf
    v_add_f32 v20, v20, v21
    v_mul_f32 v20, s100, v20
    s_nop 1
    v_mov_b32_dpp v24, v20 row_newbcast:0 row_mask:0xf bank_mask:0xf
    v_mov_b32_dpp v25, v20 row_newbcast:4 row_mask:0xf bank_mask:0xf
    v_mov_b32_dpp v26, v20 row_newbcast:8 row_mask:0xf bank_mask:0xf
    v_mov_b32_dpp v27, v20 row_newbcast:12 row_mask:0xf bank_mask:0xf
    v_perm_b32 v24, v24, v5, s36
    v_perm_b32 v25, v25, v5, s37
    v_perm_b32 v26, v26, v5, s38
    v_perm_b32 v27, v27, v5, s39
    s_mov_b32 exec_lo, 0x10001
    s_mov_b32 exec_hi, 0x10001
    buffer_store_dwordx4 v[24:27], v14, s[8:11], s65 offen sc1
    s_mov_b64 exec, -1
    s_lshl_b32 s65, s59, 15
    s_lshl_b32 s66, s5, 9
    s_add_u32 s65, s65, s66
    s_add_u32 s65, s65, 2097152
    s_add_u32 s66, s65, 8192
    s_add_u32 s67, s65, 16384
    s_add_u32 s68, s65, 24576
    v_lshrrev_b32 v48, 4, v0
    v_lshrrev_b32 v49, 4, v48
    v_and_b32 v48, 15, v48
    v_and_b32 v50, 8, v48
    v_and_b32 v51, 3, v48
    v_lshl_or_b32 v50, v51, 1, v50
    v_bfe_u32 v51, v48, 2, 1
    v_or_b32 v50, v50, v51
    s_lshl_b32 s69, s5, 14
    s_add_u32 s69, s69, 65536
    v_lshlrev_b32 v51, 10, v48
    v_lshl_add_u32 v51, v49, 8, v51
    v_lshl_add_u32 v51, v50, 4, v51
    v_add_u32 v52, s69, v51
    v_mul_u32_u24 v53, 1040, v48
    v_lshl_add_u32 v53, v49, 8, v53
    v_add_u32 v53, 131072, v53
    v_mul_u32_u24 v51, 272, v48
    v_lshl_add_u32 v50, v49, 4, v51
    s_lshl_b32 s69, s5, 6
    s_add_u32 s69, s69, 151808
    v_add_u32 v50, s69, v50
    v_lshl_add_u32 v51, v49, 5, v51
    v_add_u32 v51, 151808, v51
    v_and_b32 v14, 3, v48
    v_lshrrev_b32 v15, 2, v48
    v_and_b32 v55, 1, v49
    v_lshlrev_b32 v55, 3, v55
    v_lshl_add_u32 v55, v15, 1, v55
    v_lshrrev_b32 v56, 1, v14
    v_xor_b32 v55, v55, v56
    v_lshl_add_u32 v56, v49, 3, v15
    v_lshlrev_b32 v56, 10, v56
    v_lshl_add_u32 v56, v55, 4, v56
    v_and_b32 v14, 1, v14
    v_lshl_add_u32 v56, v14, 3, v56
    s_lshl_b32 s69, s5, 8
    s_add_u32 s69, s69, 65536
    v_add_u32 v76, s69, v56
    v_add_u32 v77, 4096, v76
    v_xor_b32 v77, 16, v77
    s_lshl_b32 s69, s5, 8
    s_add_u32 s69, s69, 131072
    v_lshrrev_b32 v14, 9, v0
    v_and_b32 v57, 0x1f0, v0
    v_lshrrev_b32 v15, 1, v57
    v_mul_u32_u24 v58, 1040, v14
    v_add_u32 v15, v15, v58
    v_add_u32 v15, s69, v15
    v_lshl_add_u32 v57, v14, 11, v57
cg_43:
    s_cmp_ge_u32 s63, 16
    s_cbranch_scc1 cg_44
    s_swappc_b64 s[30:31], s[28:29]
    s_branch cg_43
cg_44:
    s_mov_b32 s62, 0
    s_cmp_ge_u32 s6, 2
    s_cbranch_scc1 pd_49
    s_cmp_eq_u32 s7, 0
    s_cbranch_scc1 dwn_51
    s_mov_b32 s74, 0
    s_mov_b32 s95, 20
    s_mov_b32 s0, 58
    s_swappc_b64 s[72:73], s[70:71]
    s_branch dwj_52
dwn_51:
    s_waitcnt vmcnt(0)
dwj_52:
    s_branch pd_50
pd_49:
    s_sleep 18
pd_50:
poll_45:
    buffer_load_dwordx4 v[16:19], v57, s[8:11], s65 offen sc1
    s_add_u32 s69, s65, 4096
    buffer_load_dwordx4 v[20:23], v57, s[8:11], s69 offen sc1
    buffer_load_dwordx4 v[24:27], v57, s[8:11], s66 offen sc1
    s_add_u32 s69, s66, 4096
    buffer_load_dwordx4 v[28:31], v57, s[8:11], s69 offen sc1
    buffer_load_dwordx4 v[32:35], v57, s[8:11], s67 offen sc1
    s_add_u32 s69, s67, 4096
    buffer_load_dwordx4 v[36:39], v57, s[8:11], s69 offen sc1
    buffer_load_dwordx4 v[40:43], v57, s[8:11], s68 offen sc1
    s_add_u32 s69, s68, 4096
    buffer_load_dwordx4 v[44:47], v57, s[8:11], s69 offen sc1
    s_cmp_eq_u32 s7, 0
    s_cbranch_scc1 dwn_53
    s_mov_b32 s74, 0
    s_mov_b32 s95, 28
    s_mov_b32 s0, 58
    s_swappc_b64 s[72:73], s[70:71]
    s_branch dwj_54
dwn_53:
    s_waitcnt vmcnt(0)
dwj_54:
pj_47:
    v_xor_b32 v16, s32, v16
    v_xor_b32 v17, s33, v17
    v_xor_b32 v18, s34, v18
    v_xor_b32 v19, s35, v19
    v_xor_b32 v20, s32, v20
    v_xor_b32 v21, s33, v21
    v_xor_b32 v22, s34, v22
    v_xor_b32 v23, s35, v23
    v_xor_b32 v24, s32, v24
    v_xor_b32 v25, s33, v25
    v_xor_b32 v26, s34, v26
    v_xor_b32 v27, s35, v27
    v_xor_b32 v28, s32, v28
    v_xor_b32 v29, s33, v29
    v_xor_b32 v30, s34, v30
    v_xor_b32 v31, s35, v31
    v_xor_b32 v32, s32, v32
    v_xor_b32 v33, s33, v33
    v_xor_b32 v34, s34, v34
    v_xor_b32 v35, s35, v35
    v_xor_b32 v36, s32, v36
    v_xor_b32 v37, s33, v37
    v_xor_b32 v38, s34, v38
    v_xor_b32 v39, s35, v39
    v_xor_b32 v40, s32, v40
    v_xor_b32 v41, s33, v41
    v_xor_b32 v42, s34, v42
    v_xor_b32 v43, s35, v43
    v_xor_b32 v44, s32, v44
    v_xor_b32 v45, s33, v45
    v_xor_b32 v46, s34, v46
    v_xor_b32 v47, s35, v47
    v_or3_b32 v11, v16, v17, v18
    v_or3_b32 v12, v19, v20, v21
    v_or3_b32 v11, v11, v22, v23
    v_or3_b32 v12, v12, v24, v25
    v_or3_b32 v11, v11, v26, v27
    v_or3_b32 v12, v12, v28, v29
    v_or3_b32 v11, v11, v30, v31
    v_or3_b32 v12, v12, v32, v33
    v_or3_b32 v11, v11, v34, v35
    v_or3_b32 v12, v12, v36, v37
    v_or3_b32 v11, v11, v38, v39
    v_or3_b32 v12, v12, v40, v41
    v_or3_b32 v11, v11, v42, v43
    v_or3_b32 v12, v12, v44, v45
    v_or3_b32 v11, v11, v46, v47
    v_or_b32 v11, v11, v12
    v_and_b32 v11, s64, v11
    v_cmp_ne_u32 vcc, 0, v11
    s_cbranch_vccz pdone_48
    s_add_u32 s62, s62, 1
    s_cmp_lt_u32 s62, 65536
    s_cbranch_scc1 poll_45
    s_mov_b32 s88, 1
pdone_48:
    v_cvt_pk_bf16_f32 v16, v16, v17
    v_cvt_pk_bf16_f32 v17, v18, v19
    ds_write_b64 v15, v[16:17] offset:0
    v_cvt_pk_bf16_f32 v20, v20, v21
    v_cvt_pk_bf16_f32 v21, v22, v23
    ds_write_b64 v15, v[20:21] offset:2080
    v_cvt_pk_bf16_f32 v24, v24, v25
    v_cvt_pk_bf16_f32 v25, v26, v27
    ds_write_b64 v15, v[24:25] offset:4160
    v_cvt_pk_bf16_f32 v28, v28, v29
    v_cvt_pk_bf16_f32 v29, v30, v31
    ds_write_b64 v15, v[28:29] offset:6240
    v_cvt_pk_bf16_f32 v32, v32, v33
    v_cvt_pk_bf16_f32 v33, v34, v35
    ds_write_b64 v15, v[32:33] offset:8320
    v_cvt_pk_bf16_f32 v36, v36, v37
    v_cvt_pk_bf16_f32 v37, v38, v39
    ds_write_b64 v15, v[36:37] offset:10400
    v_cvt_pk_bf16_f32 v40, v40, v41
    v_cvt_pk_bf16_f32 v41, v42, v43
    ds_write_b64 v15, v[40:41] offset:12480
    v_cvt_pk_bf16_f32 v44, v44, v45
    v_cvt_pk_bf16_f32 v45, v46, v47
    ds_write_b64 v15, v[44:45] offset:14560
    s_mov_b32 s20, s46
    s_mov_b32 s21, s47
    s_mov_b32 s22, 0x1e100
    s_mov_b32 s23, 0x20000
    s_mov_b32 s65, 0
    buffer_load_dwordx4 v[80:83], v7, s[20:23], s65 offen
    s_mov_b32 s65, 32768
    buffer_load_dwordx4 v[84:87], v7, s[20:23], s65 offen
    s_mov_b32 s65, 65536
    buffer_load_dwordx4 v[88:91], v7, s[20:23], s65 offen
    s_mov_b32 s65, 98304
    buffer_load_dwordx4 v[92:95], v7, s[20:23], s65 offen
    s_cmp_eq_u32 s6, 0
    s_cbranch_scc1 t2_55
    v_lshlrev_b32 v11, 2, v0
    s_add_u32 s65, s56, 0
    buffer_load_dword v12, v11, s[8:11], s65 offen
t2_55:
    s_waitcnt lgkmcnt(0)
    s_barrier
    s_cmp_eq_u32 s7, 0
    s_cbranch_scc1 tu_56
    s_getreg_b32 s75, hwreg(HW_REG_IB_STS)
    s_bfe_u32 s94, s75, 0x20016
    s_and_b32 s75, s75, 15
    s_lshl4_add_u32 s75, s94, s75
    s_cmp_ge_u32 s75, 20
    s_cbranch_scc1 tu_56
    s_cmp_ge_u32 s63, 66
    s_cbranch_scc1 tu_56
    s_swappc_b64 s[30:31], s[28:29]
tu_56:
    ds_read_b128 v[16:19], v52
    ds_read_b128 v[20:23], v53 offset:0
    v_xor_b32 v54, 16, v52
    ds_read_b128 v[24:27], v54
    ds_read_b128 v[28:31], v53 offset:16
    v_xor_b32 v54, 32, v52
    ds_read_b128 v[32:35], v54
    ds_read_b128 v[36:39], v53 offset:32
    v_xor_b32 v54, 48, v52
    ds_read_b128 v[40:43], v54
    ds_read_b128 v[44:47], v53 offset:48
    s_waitcnt lgkmcnt(6)
    v_mfma_f32_16x16x32_bf16 v[56:59], v[16:19], v[20:23], 0
    v_xor_b32 v54, 64, v52
    ds_read_b128 v[16:19], v54
    ds_read_b128 v[20:23], v53 offset:64
    s_waitcnt lgkmcnt(6)
    v_mfma_f32_16x16x32_bf16 v[56:59], v[24:27], v[28:31], v[56:59]
    v_xor_b32 v54, 80, v52
    ds_read_b128 v[24:27], v54
    ds_read_b128 v[28:31], v53 offset:80
    s_waitcnt lgkmcnt(6)
    v_mfma_f32_16x16x32_bf16 v[56:59], v[32:35], v[36:39], v[56:59]
    v_xor_b32 v54, 96, v52
    ds_read_b128 v[32:35], v54
    ds_read_b128 v[36:39], v53 offset:96
    s_waitcnt lgkmcnt(6)
    v_mfma_f32_16x16x32_bf16 v[56:59], v[40:43], v[44:47], v[56:59]
    v_xor_b32 v54, 112, v52
    ds_read_b128 v[40:43], v54
    ds_read_b128 v[44:47], v53 offset:112
    s_waitcnt lgkmcnt(6)
    v_mfma_f32_16x16x32_bf16 v[56:59], v[16:19], v[20:23], v[56:59]
    v_xor_b32 v54, 128, v52
    ds_read_b128 v[16:19], v54
    ds_read_b128 v[20:23], v53 offset:128
    s_waitcnt lgkmcnt(6)
    v_mfma_f32_16x16x32_bf16 v[56:59], v[24:27], v[28:31], v[56:59]
    v_xor_b32 v54, 144, v52
    ds_read_b128 v[24:27], v54
    ds_read_b128 v[28:31], v53 offset:144
    s_waitcnt lgkmcnt(6)
    v_mfma_f32_16x16x32_bf16 v[56:59], v[32:35], v[36:39], v[56:59]
    v_xor_b32 v54, 160, v52
    ds_read_b128 v[32:35], v54
    ds_read_b128 v[36:39], v53 offset:160
    s_waitcnt lgkmcnt(6)
    v_mfma_f32_16x16x32_bf16 v[56:59], v[40:43], v[44:47], v[56:59]
    v_xor_b32 v54, 176, v52
    ds_read_b128 v[40:43], v54
    ds_read_b128 v[44:47], v53 offset:176
    s_waitcnt lgkmcnt(6)
    v_mfma_f32_16x16x32_bf16 v[56:59], v[16:19], v[20:23], v[56:59]
    v_xor_b32 v54, 192, v52
    ds_read_b128 v[16:19], v54
    ds_read_b128 v[20:23], v53 offset:192
    s_waitcnt lgkmcnt(6)
    v_mfma_f32_16x16x32_bf16 v[56:59], v[24:27], v[28:31], v[56:59]
    v_xor_b32 v54, 208, v52
    ds_read_b128 v[24:27], v54
    ds_read_b128 v[28:31], v53 offset:208
    s_waitcnt lgkmcnt(6)
    v_mfma_f32_16x16x32_bf16 v[56:59], v[32:35], v[36:39], v[56:59]
    v_xor_b32 v54, 224, v52
    ds_read_b128 v[32:35], v54
    ds_read_b128 v[36:39], v53 offset:224
    s_waitcnt lgkmcnt(6)
    v_mfma_f32_16x16x32_bf16 v[56:59], v[40:43], v[44:47], v[56:59]
    v_xor_b32 v54, 240, v52
    ds_read_b128 v[40:43], v54
    ds_read_b128 v[44:47], v53 offset:240
    s_waitcnt lgkmcnt(6)
    v_mfma_f32_16x16x32_bf16 v[56:59], v[16:19], v[20:23], v[56:59]
    s_waitcnt lgkmcnt(4)
    v_mfma_f32_16x16x32_bf16 v[56:59], v[24:27], v[28:31], v[56:59]
    s_waitcnt lgkmcnt(2)
    v_mfma_f32_16x16x32_bf16 v[56:59], v[32:35], v[36:39], v[56:59]
    s_waitcnt lgkmcnt(0)
    v_mfma_f32_16x16x32_bf16 v[56:59], v[40:43], v[44:47], v[56:59]
    s_nop 7
    ds_write_b128 v50, v[56:59]
    s_waitcnt lgkmcnt(0)
    s_barrier
    ds_read_b128 v[60:63], v51 offset:0
    ds_read_b128 v[64:67], v51 offset:16
    ds_read_b128 v[68:71], v51 offset:128
    ds_read_b128 v[72:75], v51 offset:144
    v_mov_b32 v78, v76
    v_mov_b32 v79, v77
    ds_read_b64_tr_b16 v[16:17], v78 offset:0
    ds_read_b64_tr_b16 v[18:19], v79 offset:0
    ds_read_b64_tr_b16 v[20:21], v78 offset:32768
    ds_read_b64_tr_b16 v[22:23], v79 offset:32768
    v_xor_b32 v78, 32, v76
    v_xor_b32 v79, 32, v77
    ds_read_b64_tr_b16 v[24:25], v78 offset:0
    ds_read_b64_tr_b16 v[26:27], v79 offset:0
    ds_read_b64_tr_b16 v[28:29], v78 offset:32768
    ds_read_b64_tr_b16 v[30:31], v79 offset:32768
    s_mov_b32 s20, s48
    s_mov_b32 s21, s49
    s_mov_b32 s22, 0x9ba0
    s_mov_b32 s23, 0x20000
    s_mul_i32 s66, s5, 5184
    s_add_u32 s66, s66, 131072
    s_add_u32 m0, s66, 0
    s_mov_b32 s65, 0
    buffer_load_dwordx4 v13, s[20:23], s65 offen  lds
    s_add_u32 m0, s66, 960
    s_mov_b32 s65, 7680
    buffer_load_dwordx4 v13, s[20:23], s65 offen  lds
    s_add_u32 m0, s66, 1920
    s_mov_b32 s65, 15360
    buffer_load_dwordx4 v13, s[20:23], s65 offen  lds
    s_add_u32 m0, s66, 2880
    s_mov_b32 s65, 23040
    buffer_load_dwordx4 v13, s[20:23], s65 offen  lds
    s_add_u32 m0, s66, 3840
    s_mov_b32 s65, 30720
    buffer_load_dwordx4 v13, s[20:23], s65 offen  lds
    s_add_u32 m0, s66, 4160
    s_mov_b32 s65, 33280
    buffer_load_dwordx4 v13, s[20:23], s65 offen  lds
    s_waitcnt lgkmcnt(8)
    v_max3_f32 v32, v60, v61, v62
    v_max3_f32 v34, v63, v64, v65
    v_max3_f32 v32, v32, v66, v67
    v_max3_f32 v34, v34, v68, v69
    v_max3_f32 v32, v32, v70, v71
    v_max3_f32 v34, v34, v72, v73
    v_max3_f32 v32, v32, v74, v75
    v_max_f32 v32, v32, v34
    v_mov_b32 v34, v32
    s_nop 1
    v_permlane16_swap_b32 v32, v34
    v_max_f32 v32, v32, v34
    v_mov_b32 v34, v32
    s_nop 1
    v_permlane32_swap_b32 v32, v34
    v_max_f32 v32, v32, v34
    v_sub_f32 v60, v60, v32
    v_sub_f32 v61, v61, v32
    v_sub_f32 v62, v62, v32
    v_sub_f32 v63, v63, v32
    v_sub_f32 v64, v64, v32
    v_sub_f32 v65, v65, v32
    v_sub_f32 v66, v66, v32
    v_sub_f32 v67, v67, v32
    v_sub_f32 v68, v68, v32
    v_sub_f32 v69, v69, v32
    v_sub_f32 v70, v70, v32
    v_sub_f32 v71, v71, v32
    v_sub_f32 v72, v72, v32
    v_sub_f32 v73, v73, v32
    v_sub_f32 v74, v74, v32
    v_sub_f32 v75, v75, v32
    v_exp_f32 v60, v60
    v_exp_f32 v61, v61
    v_exp_f32 v62, v62
    v_exp_f32 v63, v63
    v_exp_f32 v64, v64
    v_exp_f32 v65, v65
    v_exp_f32 v66, v66
    v_exp_f32 v67, v67
    v_exp_f32 v68, v68
    v_exp_f32 v69, v69
    v_exp_f32 v70, v70
    v_exp_f32 v71, v71
    v_exp_f32 v72, v72
    v_exp_f32 v73, v73
    v_exp_f32 v74, v74
    v_exp_f32 v75, v75
    v_cvt_pk_bf16_f32 v36, v60, v61
    v_cvt_pk_bf16_f32 v37, v62, v63
    v_cvt_pk_bf16_f32 v38, v64, v65
    v_cvt_pk_bf16_f32 v39, v66, v67
    v_cvt_pk_bf16_f32 v40, v68, v69
    v_cvt_pk_bf16_f32 v41, v70, v71
    v_cvt_pk_bf16_f32 v42, v72, v73
    v_cvt_pk_bf16_f32 v43, v74, v75
    v_add_f32 v60, v60, v68
    v_add_f32 v61, v61, v69
    v_add_f32 v62, v62, v70
    v_add_f32 v63, v63, v71
    v_add_f32 v64, v64, v72
    v_add_f32 v65, v65, v73
    v_add_f32 v66, v66, v74
    v_add_f32 v67, v67, v75
    v_add_f32 v60, v60, v64
    v_add_f32 v61, v61, v65
    v_add_f32 v62, v62, v66
    v_add_f32 v63, v63, v67
    v_add_f32 v60, v60, v61
    v_add_f32 v62, v62, v63
    v_add_f32 v33, v60, v62
    s_cmp_eq_u32 s7, 0
    s_cbranch_scc1 tu_57
    s_getreg_b32 s75, hwreg(HW_REG_IB_STS)
    s_bfe_u32 s94, s75, 0x20016
    s_and_b32 s75, s75, 15
    s_lshl4_add_u32 s75, s94, s75
    s_cmp_ge_u32 s75, 20
    s_cbranch_scc1 tu_57
    s_cmp_ge_u32 s63, 66
    s_cbranch_scc1 tu_57
    s_swappc_b64 s[30:31], s[28:29]
tu_57:
    v_mov_b32 v34, v33
    s_nop 1
    v_permlane16_swap_b32 v33, v34
    v_add_f32 v33, v33, v34
    v_mov_b32 v34, v33
    s_nop 1
    v_permlane32_swap_b32 v33, v34
    v_add_f32 v33, v33, v34
    v_lshrrev_b32 v14, 8, v0
    v_lshlrev_b32 v14, 16, v14
    v_and_b32 v15, 0xf0, v0
    v_add_u32 v14, v14, v15
    s_lshl_b32 s65, s98, 19
    s_lshl_b32 s66, s59, 18
    s_add_u32 s65, s65, s66
    s_lshl_b32 s66, s5, 14
    s_add_u32 s65, s65, s66
    s_and_b32 s67, s60, 15
    s_lshl_b32 s66, s67, 8
    s_add_u32 s65, s65, s66
    s_add_u32 s65, s65, 3145728
    s_lshl_b32 s68, s98, 14
    s_lshl_b32 s66, s59, 13
    s_add_u32 s68, s68, s66
    s_lshl_b32 s66, s5, 9
    s_add_u32 s68, s68, s66
    s_lshl_b32 s66, s67, 5
    s_add_u32 s68, s68, s66
    s_add_u32 s68, s68, 2162688
    v_bfe_u32 v15, v0, 6, 2
    v_lshlrev_b32 v15, 11, v15
    v_bfe_u32 v34, v0, 8, 1
    v_lshl_add_u32 v15, v34, 4, v15
    s_mov_b32 vcc_lo, 0xffff0000
    s_mov_b32 vcc_hi, 0
    v_cndmask_b32 v34, v32, v33, vcc
    s_waitcnt lgkmcnt(6)
    v_mfma_f32_16x16x32_bf16 v[44:47], v[36:39], v[16:19], 0
    v_xor_b32 v78, 64, v76
    v_xor_b32 v79, 64, v77
    ds_read_b64_tr_b16 v[16:17], v78 offset:0
    ds_read_b64_tr_b16 v[18:19], v79 offset:0
    v_mov_b32_dpp v32, v34 quad_perm:[0,0,0,0] row_mask:0xf bank_mask:0xf
    v_mov_b32_dpp v33, v34 quad_perm:[1,1,1,1] row_mask:0xf bank_mask:0xf
    v_mov_b32_dpp v35, v34 quad_perm:[3,3,3,3] row_mask:0xf bank_mask:0xf
    v_mov_b32_dpp v34, v34 quad_perm:[2,2,2,2] row_mask:0xf bank_mask:0xf
    s_waitcnt lgkmcnt(6)
    v_mfma_f32_16x16x32_bf16 v[44:47], v[40:43], v[20:23], v[44:47]
    ds_read_b64_tr_b16 v[20:21], v78 offset:32768
    ds_read_b64_tr_b16 v[22:23], v79 offset:32768
    s_waitcnt lgkmcnt(6)
    v_mfma_f32_16x16x32_bf16 v[48:51], v[36:39], v[24:27], 0
    v_xor_b32 v78, 96, v76
    v_xor_b32 v79, 96, v77
    ds_read_b64_tr_b16 v[24:25], v78 offset:0
    ds_read_b64_tr_b16 v[26:27], v79 offset:0
    v_perm_b32 v32, v32, v5, s36
    v_perm_b32 v33, v33, v5, s37
    v_perm_b32 v34, v34, v5, s38
    v_perm_b32 v35, v35, v5, s39
    s_waitcnt lgkmcnt(6)
    v_mfma_f32_16x16x32_bf16 v[48:51], v[40:43], v[28:31], v[48:51]
    ds_read_b64_tr_b16 v[28:29], v78 offset:32768
    ds_read_b64_tr_b16 v[30:31], v79 offset:32768
    s_waitcnt lgkmcnt(6)
    v_mfma_f32_16x16x32_bf16 v[52:55], v[36:39], v[16:19], 0
    v_xor_b32 v78, 128, v76
    v_xor_b32 v79, 128, v77
    ds_read_b64_tr_b16 v[16:17], v78 offset:0
    ds_read_b64_tr_b16 v[18:19], v79 offset:0
    s_waitcnt lgkmcnt(6)
    v_mfma_f32_16x16x32_bf16 v[52:55], v[40:43], v[20:23], v[52:55]
    ds_read_b64_tr_b16 v[20:21], v78 offset:32768
    ds_read_b64_tr_b16 v[22:23], v79 offset:32768
    s_waitcnt lgkmcnt(6)
    v_mfma_f32_16x16x32_bf16 v[56:59], v[36:39], v[24:27], 0
    v_xor_b32 v78, 160, v76
    v_xor_b32 v79, 160, v77
    ds_read_b64_tr_b16 v[24:25], v78 offset:0
    ds_read_b64_tr_b16 v[26:27], v79 offset:0
    s_waitcnt lgkmcnt(6)
    v_mfma_f32_16x16x32_bf16 v[56:59], v[40:43], v[28:31], v[56:59]
    ds_read_b64_tr_b16 v[28:29], v78 offset:32768
    ds_read_b64_tr_b16 v[30:31], v79 offset:32768
    v_cvt_pk_bf16_f32 v44, v44, v45
    v_cvt_pk_bf16_f32 v45, v46, v47
    v_cvt_pk_bf16_f32 v46, v48, v49
    v_cvt_pk_bf16_f32 v47, v50, v51
    s_cmp_eq_u32 s89, 0
    s_cbranch_scc1 ls_58
    s_add_u32 s66, s65, 0
    buffer_store_dwordx4 v[44:47], v14, s[8:11], s66 offen
    s_branch ls_59
ls_58:
    s_add_u32 s66, s65, 0
    buffer_store_dwordx4 v[44:47], v14, s[8:11], s66 offen sc1
ls_59:
    s_waitcnt lgkmcnt(6)
    v_mfma_f32_16x16x32_bf16 v[60:63], v[36:39], v[16:19], 0
    v_xor_b32 v78, 192, v76
    v_xor_b32 v79, 192, v77
    ds_read_b64_tr_b16 v[16:17], v78 offset:0
    ds_read_b64_tr_b16 v[18:19], v79 offset:0
    s_waitcnt lgkmcnt(6)
    v_mfma_f32_16x16x32_bf16 v[60:63], v[40:43], v[20:23], v[60:63]
    ds_read_b64_tr_b16 v[20:21], v78 offset:32768
    ds_read_b64_tr_b16 v[22:23], v79 offset:32768
    s_waitcnt lgkmcnt(6)
    v_mfma_f32_16x16x32_bf16 v[64:67], v[36:39], v[24:27], 0
    v_xor_b32 v78, 224, v76
    v_xor_b32 v79, 224, v77
    ds_read_b64_tr_b16 v[24:25], v78 offset:0
    ds_read_b64_tr_b16 v[26:27], v79 offset:0
    s_waitcnt lgkmcnt(6)
    v_mfma_f32_16x16x32_bf16 v[64:67], v[40:43], v[28:31], v[64:67]
    ds_read_b64_tr_b16 v[28:29], v78 offset:32768
    ds_read_b64_tr_b16 v[30:31], v79 offset:32768
    v_cvt_pk_bf16_f32 v52, v52, v53
    v_cvt_pk_bf16_f32 v53, v54, v55
    v_cvt_pk_bf16_f32 v54, v56, v57
    v_cvt_pk_bf16_f32 v55, v58, v59
    s_cmp_eq_u32 s89, 0
    s_cbranch_scc1 ls_60
    s_add_u32 s66, s65, 4096
    buffer_store_dwordx4 v[52:55], v14, s[8:11], s66 offen
    s_branch ls_61
ls_60:
    s_add_u32 s66, s65, 4096
    buffer_store_dwordx4 v[52:55], v14, s[8:11], s66 offen sc1
ls_61:
    s_waitcnt lgkmcnt(6)
    v_mfma_f32_16x16x32_bf16 v[68:71], v[36:39], v[16:19], 0
    s_waitcnt lgkmcnt(4)
    v_mfma_f32_16x16x32_bf16 v[68:71], v[40:43], v[20:23], v[68:71]
    s_waitcnt lgkmcnt(2)
    v_mfma_f32_16x16x32_bf16 v[72:75], v[36:39], v[24:27], 0
    s_waitcnt lgkmcnt(0)
    v_mfma_f32_16x16x32_bf16 v[72:75], v[40:43], v[28:31], v[72:75]
    v_cvt_pk_bf16_f32 v60, v60, v61
    v_cvt_pk_bf16_f32 v61, v62, v63
    v_cvt_pk_bf16_f32 v62, v64, v65
    v_cvt_pk_bf16_f32 v63, v66, v67
    s_cmp_eq_u32 s89, 0
    s_cbranch_scc1 ls_62
    s_add_u32 s66, s65, 8192
    buffer_store_dwordx4 v[60:63], v14, s[8:11], s66 offen
    s_branch ls_63
ls_62:
    s_add_u32 s66, s65, 8192
    buffer_store_dwordx4 v[60:63], v14, s[8:11], s66 offen sc1
ls_63:
    v_cvt_pk_bf16_f32 v68, v68, v69
    v_cvt_pk_bf16_f32 v69, v70, v71
    v_cvt_pk_bf16_f32 v70, v72, v73
    v_cvt_pk_bf16_f32 v71, v74, v75
    s_cmp_eq_u32 s89, 0
    s_cbranch_scc1 ls_64
    s_add_u32 s66, s65, 12288
    buffer_store_dwordx4 v[68:71], v14, s[8:11], s66 offen
    s_branch ls_65
ls_64:
    s_add_u32 s66, s65, 12288
    buffer_store_dwordx4 v[68:71], v14, s[8:11], s66 offen sc1
ls_65:
    v_bfe_u32 v14, v0, 4, 2
    v_lshlrev_b32 v14, 2, v14
    v_lshrrev_b32 v36, 8, v0
    v_add_u32 v14, v14, v36
    v_lshlrev_b32 v14, 5, v14
    s_lshl_b32 s65, s98, 5
    s_add_u32 s65, s65, s99
    s_lshl_b32 s67, s65, 9
    s_add_u32 s67, s67, 2162688
    s_waitcnt vmcnt(0)
    s_cmp_eq_u32 s89, 0
    s_cbranch_scc1 ls_66
    s_mov_b32 exec_lo, 0x11111111
    s_mov_b32 exec_hi, 0
    buffer_store_dwordx4 v[32:35], v15, s[8:11], s68 offen
    s_branch ls_67
ls_66:
    s_mov_b32 exec_lo, 0x11111111
    s_mov_b32 exec_hi, 0
    buffer_store_dwordx4 v[32:35], v15, s[8:11], s68 offen sc1
ls_67:
    s_mov_b64 exec, -1
    s_mov_b32 s62, 0
    s_cmp_ge_u32 s6, 2
    s_cbranch_scc1 pd_72
    s_cmp_eq_u32 s7, 0
    s_cbranch_scc1 dwn_74
    s_mov_b32 s74, 0
    s_mov_b32 s95, 20
    s_mov_b32 s0, 72
    s_swappc_b64 s[72:73], s[70:71]
    s_branch dwj_75
dwn_74:
    s_waitcnt vmcnt(0)
dwj_75:
    s_branch pd_73
pd_72:
    s_sleep 4
pd_73:
poll_68:
    buffer_load_dwordx4 v[48:51], v14, s[8:11], s67 offen sc1
    buffer_load_dwordx4 v[52:55], v14, s[8:11], s67 offen offset:16 sc1
    s_cmp_eq_u32 s7, 0
    s_cbranch_scc1 dwn_76
    s_mov_b32 s74, 0
    s_mov_b32 s95, 22
    s_mov_b32 s0, 72
    s_swappc_b64 s[72:73], s[70:71]
    s_branch dwj_77
dwn_76:
    s_waitcnt vmcnt(0)
dwj_77:
pj_70:
    v_xor_b32 v48, s32, v48
    v_xor_b32 v49, s33, v49
    v_xor_b32 v50, s34, v50
    v_xor_b32 v51, s35, v51
    v_xor_b32 v52, s32, v52
    v_xor_b32 v53, s33, v53
    v_xor_b32 v54, s34, v54
    v_xor_b32 v55, s35, v55
    v_or3_b32 v11, v48, v49, v50
    v_or3_b32 v12, v51, v52, v53
    v_or3_b32 v11, v11, v54, v55
    v_or_b32 v11, v11, v12
    v_and_b32 v11, s64, v11
    v_cmp_ne_u32 vcc, 0, v11
    s_cbranch_vccz pdone_71
    s_add_u32 s62, s62, 1
    s_cmp_lt_u32 s62, 65536
    s_cbranch_scc1 poll_68
    s_mov_b32 s88, 1
pdone_71:
    buffer_load_dwordx4 v[16:19], v0, s[8:11], s56 offen offset:0 sc1
    buffer_load_dwordx4 v[20:23], v0, s[8:11], s56 offen offset:1024 sc1
    buffer_load_dwordx4 v[24:27], v0, s[8:11], s56 offen offset:2048 sc1
    buffer_load_dwordx4 v[28:31], v0, s[8:11], s56 offen offset:3072 sc1
    v_max_f32_dpp v56, v48, v48 quad_perm:[1,0,3,2] row_mask:0xf bank_mask:0xf
    v_max_f32_dpp v57, v49, v49 quad_perm:[1,0,3,2] row_mask:0xf bank_mask:0xf
    v_max_f32_dpp v58, v50, v50 quad_perm:[1,0,3,2] row_mask:0xf bank_mask:0xf
    v_max_f32_dpp v59, v51, v51 quad_perm:[1,0,3,2] row_mask:0xf bank_mask:0xf
    v_max_f32_dpp v56, v56, v56 quad_perm:[2,3,0,1] row_mask:0xf bank_mask:0xf
    v_max_f32_dpp v57, v57, v57 quad_perm:[2,3,0,1] row_mask:0xf bank_mask:0xf
    v_max_f32_dpp v58, v58, v58 quad_perm:[2,3,0,1] row_mask:0xf bank_mask:0xf
    v_max_f32_dpp v59, v59, v59 quad_perm:[2,3,0,1] row_mask:0xf bank_mask:0xf
    v_mov_b32 v68, v56
    v_mov_b32 v69, v57
    v_mov_b32 v70, v58
    v_mov_b32 v71, v59
    v_permlane16_swap_b32 v56, v68
    v_permlane16_swap_b32 v57, v69
    v_permlane16_swap_b32 v58, v70
    v_permlane16_swap_b32 v59, v71
    v_max_f32 v56, v56, v68
    v_max_f32 v57, v57, v69
    v_max_f32 v58, v58, v70
    v_max_f32 v59, v59, v71
    v_mov_b32 v68, v56
    v_mov_b32 v69, v57
    v_mov_b32 v70, v58
    v_mov_b32 v71, v59
    v_permlane32_swap_b32 v56, v68
    v_permlane32_swap_b32 v57, v69
    v_permlane32_swap_b32 v58, v70
    v_permlane32_swap_b32 v59, v71
    v_max_f32 v56, v56, v68
    v_max_f32 v57, v57, v69
    v_max_f32 v58, v58, v70
    v_max_f32 v59, v59, v71
    v_sub_f32 v60, v48, v56
    v_sub_f32 v61, v49, v57
    v_sub_f32 v62, v50, v58
    v_sub_f32 v63, v51, v59
    v_exp_f32 v60, v60
    v_exp_f32 v61, v61
    v_exp_f32 v62, v62
    v_exp_f32 v63, v63
    v_mul_f32 v64, v60, v52
    v_mul_f32 v65, v61, v53
    v_mul_f32 v66, v62, v54
    v_mul_f32 v67, v63, v55
    v_add_f32_dpp v64, v64, v64 quad_perm:[1,0,3,2] row_mask:0xf bank_mask:0xf
    v_add_f32_dpp v65, v65, v65 quad_perm:[1,0,3,2] row_mask:0xf bank_mask:0xf
    v_add_f32_dpp v66, v66, v66 quad_perm:[1,0,3,2] row_mask:0xf bank_mask:0xf
    v_add_f32_dpp v67, v67, v67 quad_perm:[1,0,3,2] row_mask:0xf bank_mask:0xf
    v_add_f32_dpp v64, v64, v64 quad_perm:[2,3,0,1] row_mask:0xf bank_mask:0xf
    v_add_f32_dpp v65, v65, v65 quad_perm:[2,3,0,1] row_mask:0xf bank_mask:0xf
    v_add_f32_dpp v66, v66, v66 quad_perm:[2,3,0,1] row_mask:0xf bank_mask:0xf
    v_add_f32_dpp v67, v67, v67 quad_perm:[2,3,0,1] row_mask:0xf bank_mask:0xf
    v_mov_b32 v68, v64
    v_mov_b32 v69, v65
    v_mov_b32 v70, v66
    v_mov_b32 v71, v67
    v_permlane16_swap_b32 v64, v68
    v_permlane16_swap_b32 v65, v69
    v_permlane16_swap_b32 v66, v70
    v_permlane16_swap_b32 v67, v71
    v_add_f32 v64, v64, v68
    v_add_f32 v65, v65, v69
    v_add_f32 v66, v66, v70
    v_add_f32 v67, v67, v71
    v_mov_b32 v68, v64
    v_mov_b32 v69, v65
    v_mov_b32 v70, v66
    v_mov_b32 v71, v67
    v_permlane32_swap_b32 v64, v68
    v_permlane32_swap_b32 v65, v69
    v_permlane32_swap_b32 v66, v70
    v_permlane32_swap_b32 v67, v71
    v_add_f32 v64, v64, v68
    v_add_f32 v65, v65, v69
    v_add_f32 v66, v66, v70
    v_add_f32 v67, v67, v71
    s_cmp_eq_u32 s7, 0
    s_cbranch_scc1 dwn_78
    s_mov_b32 s74, 0
    s_mov_b32 s95, 24
    s_mov_b32 s0, 76
    s_swappc_b64 s[72:73], s[70:71]
    s_branch dwj_79
dwn_78:
    s_waitcnt vmcnt(0)
dwj_79:
    v_lshlrev_b32 v32, 16, v16
    v_and_b32 v33, 0xffff0000, v16
    v_lshlrev_b32 v34, 16, v17
    v_and_b32 v35, 0xffff0000, v17
    v_lshlrev_b32 v36, 16, v18
    v_and_b32 v37, 0xffff0000, v18
    v_lshlrev_b32 v38, 16, v19
    v_and_b32 v39, 0xffff0000, v19
    v_mul_f32_dpp v48, v60, v32 row_newbcast:0 row_mask:0xf bank_mask:0xf
    v_mul_f32_dpp v49, v61, v33 row_newbcast:0 row_mask:0xf bank_mask:0xf
    v_mul_f32_dpp v50, v62, v34 row_newbcast:0 row_mask:0xf bank_mask:0xf
    v_mul_f32_dpp v51, v63, v35 row_newbcast:0 row_mask:0xf bank_mask:0xf
    v_mul_f32_dpp v52, v60, v36 row_newbcast:0 row_mask:0xf bank_mask:0xf
    v_mul_f32_dpp v53, v61, v37 row_newbcast:0 row_mask:0xf bank_mask:0xf
    v_mul_f32_dpp v54, v62, v38 row_newbcast:0 row_mask:0xf bank_mask:0xf
    v_mul_f32_dpp v55, v63, v39 row_newbcast:0 row_mask:0xf bank_mask:0xf
    v_lshlrev_b32 v32, 16, v20
    v_and_b32 v33, 0xffff0000, v20
    v_lshlrev_b32 v34, 16, v21
    v_and_b32 v35, 0xffff0000, v21
    v_lshlrev_b32 v36, 16, v22
    v_and_b32 v37, 0xffff0000, v22
    v_lshlrev_b32 v38, 16, v23
    v_and_b32 v39, 0xffff0000, v23
    v_fmac_f32_dpp v48, v60, v32 row_newbcast:1 row_mask:0xf bank_mask:0xf
    v_fmac_f32_dpp v49, v61, v33 row_newbcast:1 row_mask:0xf bank_mask:0xf
    v_fmac_f32_dpp v50, v62, v34 row_newbcast:1 row_mask:0xf bank_mask:0xf
    v_fmac_f32_dpp v51, v63, v35 row_newbcast:1 row_mask:0xf bank_mask:0xf
    v_fmac_f32_dpp v52, v60, v36 row_newbcast:1 row_mask:0xf bank_mask:0xf
    v_fmac_f32_dpp v53, v61, v37 row_newbcast:1 row_mask:0xf bank_mask:0xf
    v_fmac_f32_dpp v54, v62, v38 row_newbcast:1 row_mask:0xf bank_mask:0xf
    v_fmac_f32_dpp v55, v63, v39 row_newbcast:1 row_mask:0xf bank_mask:0xf
    v_lshlrev_b32 v32, 16, v24
    v_and_b32 v33, 0xffff0000, v24
    v_lshlrev_b32 v34, 16, v25
    v_and_b32 v35, 0xffff0000, v25
    v_lshlrev_b32 v36, 16, v26
    v_and_b32 v37, 0xffff0000, v26
    v_lshlrev_b32 v38, 16, v27
    v_and_b32 v39, 0xffff0000, v27
    v_fmac_f32_dpp v48, v60, v32 row_newbcast:2 row_mask:0xf bank_mask:0xf
    v_fmac_f32_dpp v49, v61, v33 row_newbcast:2 row_mask:0xf bank_mask:0xf
    v_fmac_f32_dpp v50, v62, v34 row_newbcast:2 row_mask:0xf bank_mask:0xf
    v_fmac_f32_dpp v51, v63, v35 row_newbcast:2 row_mask:0xf bank_mask:0xf
    v_fmac_f32_dpp v52, v60, v36 row_newbcast:2 row_mask:0xf bank_mask:0xf
    v_fmac_f32_dpp v53, v61, v37 row_newbcast:2 row_mask:0xf bank_mask:0xf
    v_fmac_f32_dpp v54, v62, v38 row_newbcast:2 row_mask:0xf bank_mask:0xf
    v_fmac_f32_dpp v55, v63, v39 row_newbcast:2 row_mask:0xf bank_mask:0xf
    v_lshlrev_b32 v32, 16, v28
    v_and_b32 v33, 0xffff0000, v28
    v_lshlrev_b32 v34, 16, v29
    v_and_b32 v35, 0xffff0000, v29
    v_lshlrev_b32 v36, 16, v30
    v_and_b32 v37, 0xffff0000, v30
    v_lshlrev_b32 v38, 16, v31
    v_and_b32 v39, 0xffff0000, v31
    v_fmac_f32_dpp v48, v60, v32 row_newbcast:3 row_mask:0xf bank_mask:0xf
    v_fmac_f32_dpp v49, v61, v33 row_newbcast:3 row_mask:0xf bank_mask:0xf
    v_fmac_f32_dpp v50, v62, v34 row_newbcast:3 row_mask:0xf bank_mask:0xf
    v_fmac_f32_dpp v51, v63, v35 row_newbcast:3 row_mask:0xf bank_mask:0xf
    v_fmac_f32_dpp v52, v60, v36 row_newbcast:3 row_mask:0xf bank_mask:0xf
    v_fmac_f32_dpp v53, v61, v37 row_newbcast:3 row_mask:0xf bank_mask:0xf
    v_fmac_f32_dpp v54, v62, v38 row_newbcast:3 row_mask:0xf bank_mask:0xf
    v_fmac_f32_dpp v55, v63, v39 row_newbcast:3 row_mask:0xf bank_mask:0xf
    v_permlane32_swap_b32 v48, v52
    v_permlane32_swap_b32 v49, v53
    v_permlane32_swap_b32 v50, v54
    v_permlane32_swap_b32 v51, v55
    v_add_f32 v48, v48, v52
    v_add_f32 v49, v49, v53
    v_add_f32 v50, v50, v54
    v_add_f32 v51, v51, v55
    v_mov_b32 v68, v48
    v_mov_b32 v69, v49
    v_mov_b32 v70, v50
    v_mov_b32 v71, v51
    v_permlane16_swap_b32 v48, v68
    v_permlane16_swap_b32 v49, v69
    v_permlane16_swap_b32 v50, v70
    v_permlane16_swap_b32 v51, v71
    v_add_f32 v48, v48, v68
    v_add_f32 v49, v49, v69
    v_add_f32 v50, v50, v70
    v_add_f32 v51, v51, v71
    v_bfe_u32 v14, v0, 9, 1
    v_lshlrev_b32 v14, 11, v14
    v_and_b32 v15, 0xf0, v0
    v_add_u32 v14, v14, v15
    s_lshr_b32 s65, s99, 2
    s_lshl_b32 s65, s65, 16
    s_and_b32 s66, s99, 3
    s_lshl_b32 s66, s66, 14
    s_add_u32 s65, s65, s66
    s_lshl_b32 s66, s5, 12
    s_add_u32 s65, s65, s66
    s_lshl_b32 s66, s98, 8
    s_add_u32 s65, s65, s66
    s_add_u32 s65, s65, 2359296
    v_perm_b32 v48, v48, v5, s36
    v_perm_b32 v49, v49, v5, s37
    v_perm_b32 v50, v50, v5, s38
    v_perm_b32 v51, v51, v5, s39
    s_mov_b32 exec_lo, 0xffff
    s_mov_b32 exec_hi, 0xffff
    buffer_store_dwordx4 v[48:51], v14, s[8:11], s65 offen sc1
    s_mov_b64 exec, -1
    s_and_b32 s66, s99, 3
    s_or_b32 s66, s66, s5
    s_cmp_lg_u32 s66, 0
    s_cbranch_scc1 ml2_80
    s_mov_b64 vcc, 2
    v_cndmask_b32 v56, v56, v57, vcc
    v_cndmask_b32 v64, v64, v65, vcc
    s_mov_b64 vcc, 4
    v_cndmask_b32 v56, v56, v58, vcc
    v_cndmask_b32 v64, v64, v66, vcc
    s_mov_b64 vcc, 8
    v_cndmask_b32 v56, v56, v59, vcc
    v_cndmask_b32 v64, v64, v67, vcc
    v_mov_b32 v57, v64
    v_mov_b32 v58, 0
    v_mov_b32 v59, 0
    v_perm_b32 v56, v56, v5, s36
    v_perm_b32 v57, v57, v5, s37
    v_perm_b32 v58, v58, v5, s38
    v_perm_b32 v59, v59, v5, s39
    s_lshl_b32 s66, s99, 7
    s_lshl_b32 s67, s98, 4
    s_add_u32 s66, s66, s67
    s_add_u32 s66, s66, 2883584
    v_lshlrev_b32 v15, 3, v0
    s_mov_b64 exec, 15
    buffer_store_dwordx4 v[56:59], v15, s[8:11], s66 offen sc1
    s_mov_b64 exec, -1
ml2_80:
    v_bfe_u32 v15, v0, 6, 2
    v_bfe_u32 v14, v0, 4, 2
    v_lshlrev_b32 v14, 2, v14
    v_lshrrev_b32 v32, 8, v0
    v_add_u32 v14, v14, v32
    v_lshlrev_b32 v14, 4, v14
    v_lshl_add_u32 v14, v15, 8, v14
    v_lshlrev_b32 v15, 4, v15
    s_lshr_b32 s65, s3, 2
    s_lshl_b32 s65, s65, 16
    s_lshl_b32 s66, s4, 13
    s_add_u32 s65, s65, s66
    s_lshl_b32 s66, s5, 11
    s_add_u32 s65, s65, s66
    s_add_u32 s65, s65, 2359296
    s_lshl_b32 s67, s3, 7
    s_add_u32 s67, s67, 2883584
    s_mov_b32 s62, 0
    s_cmp_ge_u32 s6, 2
    s_cbranch_scc1 pd_85
    s_cmp_eq_u32 s7, 0
    s_cbranch_scc1 dwn_87
    s_mov_b32 s74, 0
    s_mov_b32 s95, 20
    s_mov_b32 s0, 94
    s_swappc_b64 s[72:73], s[70:71]
    s_branch dwj_88
dwn_87:
    s_waitcnt vmcnt(0)
dwj_88:
    s_branch pd_86
pd_85:
    s_sleep 14
pd_86:
poll_81:
    buffer_load_dwordx4 v[24:27], v15, s[8:11], s67 offen sc1
    buffer_load_dwordx4 v[28:31], v15, s[8:11], s67 offen offset:64 sc1
    buffer_load_dwordx4 v[16:19], v14, s[8:11], s65 offen sc1
    buffer_load_dwordx4 v[20:23], v14, s[8:11], s65 offen offset:1024 sc1
    s_cmp_eq_u32 s7, 0
    s_cbranch_scc1 dwn_89
    s_mov_b32 s74, 0
    s_mov_b32 s95, 24
    s_mov_b32 s0, 94
    s_swappc_b64 s[72:73], s[70:71]
    s_branch dwj_90
dwn_89:
    s_waitcnt vmcnt(0)
dwj_90:
pj_83:
    v_xor_b32 v24, s32, v24
    v_xor_b32 v25, s33, v25
    v_xor_b32 v26, s34, v26
    v_xor_b32 v27, s35, v27
    v_xor_b32 v28, s32, v28
    v_xor_b32 v29, s33, v29
    v_xor_b32 v30, s34, v30
    v_xor_b32 v31, s35, v31
    v_xor_b32 v16, s32, v16
    v_xor_b32 v17, s33, v17
    v_xor_b32 v18, s34, v18
    v_xor_b32 v19, s35, v19
    v_xor_b32 v20, s32, v20
    v_xor_b32 v21, s33, v21
    v_xor_b32 v22, s34, v22
    v_xor_b32 v23, s35, v23
    v_or3_b32 v11, v24, v25, v26
    v_or3_b32 v12, v27, v28, v29
    v_or3_b32 v11, v11, v30, v31
    v_or3_b32 v12, v12, v16, v17
    v_or3_b32 v11, v11, v18, v19
    v_or3_b32 v12, v12, v20, v21
    v_or3_b32 v11, v11, v22, v23
    v_or_b32 v11, v11, v12
    v_and_b32 v11, s64, v11
    v_cmp_ne_u32 vcc, 0, v11
    s_cbranch_vccz pdone_84
    s_add_u32 s62, s62, 1
    s_cmp_lt_u32 s62, 65536
    s_cbranch_scc1 poll_81
    s_mov_b32 s88, 1
pdone_84:
    v_max_f32 v32, v24, v28
    s_and_b32 s66, s3, 3
    s_cmp_eq_u32 s66, 1
    s_cbranch_scc1 sel_92
    s_cmp_eq_u32 s66, 2
    s_cbranch_scc1 sel_93
    s_cmp_eq_u32 s66, 3
    s_cbranch_scc1 sel_94
    s_branch selj_95
sel_92:
    v_mov_b32 v16, v17
    v_mov_b32 v20, v21
    s_branch selj_95
sel_93:
    v_mov_b32 v16, v18
    v_mov_b32 v20, v22
    s_branch selj_95
sel_94:
    v_mov_b32 v16, v19
    v_mov_b32 v20, v23
selj_95:
    v_max_f32_dpp v32, v32, v32 row_ror:4 row_mask:0xf bank_mask:0xf
    s_nop 1
    v_max_f32_dpp v32, v32, v32 row_ror:8 row_mask:0xf bank_mask:0xf
    v_sub_f32 v33, v24, v32
    v_sub_f32 v34, v28, v32
    v_exp_f32 v33, v33
    v_exp_f32 v34, v34
    v_mul_f32 v35, v33, v25
    v_mul_f32 v16, v33, v16
    v_fmac_f32 v35, v34, v29
    v_fmac_f32 v16, v34, v20
    s_nop 0
    v_add_f32_dpp v35, v35, v35 row_ror:4 row_mask:0xf bank_mask:0xf
    v_add_f32_dpp v16, v16, v16 row_ror:4 row_mask:0xf bank_mask:0xf
    s_nop 0
    v_add_f32_dpp v35, v35, v35 row_ror:8 row_mask:0xf bank_mask:0xf
    v_add_f32_dpp v16, v16, v16 row_ror:8 row_mask:0xf bank_mask:0xf
    v_rcp_f32 v35, v35
    s_nop 0
    v_mul_f32 v16, v16, v35
    v_cvt_pk_bf16_f32 v14, v16, v16
    s_nop 1
    v_and_b32_dpp v20, v14, v1 row_newbcast:0 row_mask:0xf bank_mask:0xf
    v_and_b32_dpp v21, v14, v2 row_newbcast:0 row_mask:0xf bank_mask:0xf
    v_and_b32_dpp v22, v14, v3 row_newbcast:0 row_mask:0xf bank_mask:0xf
    v_and_b32_dpp v23, v14, v4 row_newbcast:0 row_mask:0xf bank_mask:0xf
    v_and_b32_dpp v24, v14, v1 row_newbcast:1 row_mask:0xf bank_mask:0xf
    v_and_b32_dpp v25, v14, v2 row_newbcast:1 row_mask:0xf bank_mask:0xf
    v_and_b32_dpp v26, v14, v3 row_newbcast:1 row_mask:0xf bank_mask:0xf
    v_and_b32_dpp v27, v14, v4 row_newbcast:1 row_mask:0xf bank_mask:0xf
    v_mfma_f32_16x16x32_bf16 v[16:19], v[20:23], v[80:83], 0
    v_and_b32_dpp v20, v14, v1 row_newbcast:2 row_mask:0xf bank_mask:0xf
    v_and_b32_dpp v21, v14, v2 row_newbcast:2 row_mask:0xf bank_mask:0xf
    v_and_b32_dpp v22, v14, v3 row_newbcast:2 row_mask:0xf bank_mask:0xf
    v_and_b32_dpp v23, v14, v4 row_newbcast:2 row_mask:0xf bank_mask:0xf
    v_mfma_f32_16x16x32_bf16 v[16:19], v[24:27], v[84:87], v[16:19]
    v_and_b32_dpp v24, v14, v1 row_newbcast:3 row_mask:0xf bank_mask:0xf
    v_and_b32_dpp v25, v14, v2 row_newbcast:3 row_mask:0xf bank_mask:0xf
    v_and_b32_dpp v26, v14, v3 row_newbcast:3 row_mask:0xf bank_mask:0xf
    v_and_b32_dpp v27, v14, v4 row_newbcast:3 row_mask:0xf bank_mask:0xf
    v_mfma_f32_16x16x32_bf16 v[16:19], v[20:23], v[88:91], v[16:19]
    s_nop 0
    v_mfma_f32_16x16x32_bf16 v[16:19], v[24:27], v[92:95], v[16:19]
    s_mov_b32 exec_hi, 1
    s_nop 6
    ds_write_b128 v10, v[16:19] offset:0
    s_mov_b32 exec_hi, -1
    s_lshl_b32 s65, s3, 3
    s_add_u32 s65, s65, s4
    s_lshl_b32 s65, s65, 10
    s_add_u32 s65, s65, 1572864
    s_waitcnt lgkmcnt(0)
    s_barrier
    s_cmp_lg_u32 s5, 0
    s_cbranch_scc1 uvfin_96
    v_add_u32 v11, 156160, v0
    ds_read_b128 v[16:19], v11 offset:0
    ds_read_b128 v[20:23], v11 offset:1056
    ds_read_b128 v[24:27], v11 offset:2112
    ds_read_b128 v[28:31], v11 offset:3168
    s_mov_b32 s90, 0x3e000000
    s_waitcnt lgkmcnt(0)
    v_add_f32 v16, v16, v20
    v_add_f32 v24, v24, v28
    v_add_f32 v17, v17, v21
    v_add_f32 v25, v25, v29
    v_add_f32 v18, v18, v22
    v_add_f32 v26, v26, v30
    v_add_f32 v19, v19, v23
    v_add_f32 v27, v27, v31
    v_add_f32 v16, v16, v24
    v_add_f32 v17, v17, v25
    v_add_f32 v18, v18, v26
    v_add_f32 v19, v19, v27
    v_writelane_b32 v16, 0, 32
    v_writelane_b32 v17, s90, 32
    v_perm_b32 v16, v16, v5, s36
    v_perm_b32 v17, v17, v5, s37
    v_perm_b32 v18, v18, v5, s38
    v_perm_b32 v19, v19, v5, s39
    s_mov_b32 exec_hi, 1
    s_cmp_eq_u32 s89, 0
    s_cbranch_scc1 ls_97
    buffer_store_dwordx4 v[16:19], v0, s[8:11], s65 offen
    s_branch ls_98
ls_97:
    buffer_store_dwordx4 v[16:19], v0, s[8:11], s65 offen sc1
ls_98:
    s_mov_b32 exec_hi, -1
uvfin_96:
    s_branch L_opart
L_bmid:
kw_99:
    s_cmp_ge_u32 s63, 98
    s_cbranch_scc1 kw_100
    s_swappc_b64 s[30:31], s[28:29]
    s_waitcnt vmcnt(16)
    s_branch kw_99
kw_100:
    s_waitcnt vmcnt(16)
    s_mov_b32 s20, s50
    s_mov_b32 s21, s51
    s_mov_b32 s22, 0x9ba0
    s_mov_b32 s23, 0x20000
    s_mul_i32 s66, s5, 5184
    s_add_u32 s66, s66, 131072
    v_mfma_f32_16x16x32_bf16 v[16:19], v[44:47], a[0:3], 0
    v_mfma_f32_16x16x32_bf16 v[16:19], v[48:51], a[4:7], v[16:19]
    v_mfma_f32_16x16x32_bf16 v[16:19], v[52:55], a[8:11], v[16:19]
    s_mov_b32 s67, 61440
    buffer_load_dwordx4 v[80:83], v9, s[16:19], s67 offen offset:0
    v_mfma_f32_16x16x32_bf16 v[16:19], v[56:59], a[12:15], v[16:19]
    v_mfma_f32_16x16x32_bf16 v[20:23], v[44:47], a[16:19], 0
    v_mfma_f32_16x16x32_bf16 v[20:23], v[48:51], a[20:23], v[20:23]
    v_mfma_f32_16x16x32_bf16 v[20:23], v[52:55], a[24:27], v[20:23]
    buffer_load_dwordx4 v[84:87], v9, s[16:19], s67 offen offset:2048
    v_mfma_f32_16x16x32_bf16 v[20:23], v[56:59], a[28:31], v[20:23]
    s_cmp_eq_u32 s7, 0
    s_cbranch_scc1 tu_101
    s_getreg_b32 s75, hwreg(HW_REG_IB_STS)
    s_bfe_u32 s94, s75, 0x20016
    s_and_b32 s75, s75, 15
    s_lshl4_add_u32 s75, s94, s75
    s_cmp_ge_u32 s75, 16
    s_cbranch_scc1 tu_101
    s_swappc_b64 s[30:31], s[28:29]
tu_101:
    v_mfma_f32_16x16x32_bf16 v[24:27], v[44:47], a[32:35], 0
    v_mov_b32_dpp v28, v16 quad_perm:[0,0,0,0] row_mask:0xf bank_mask:0xf
    v_mfma_f32_16x16x32_bf16 v[24:27], v[48:51], a[36:39], v[24:27]
    v_mov_b32_dpp v14, v18 quad_perm:[2,2,2,2] row_mask:0xf bank_mask:0xf
    v_mfma_f32_16x16x32_bf16 v[24:27], v[52:55], a[40:43], v[24:27]
    v_add_f32_dpp v28, v17, v28 quad_perm:[1,1,1,1] row_mask:0xf bank_mask:0xf
    buffer_load_dwordx4 v[88:91], v9, s[16:19], s67 offen offset:512
    v_mfma_f32_16x16x32_bf16 v[24:27], v[56:59], a[44:47], v[24:27]
    v_add_f32_dpp v14, v19, v14 quad_perm:[3,3,3,3] row_mask:0xf bank_mask:0xf
    v_add_f32 v28, v28, v14
    v_mfma_f32_16x16x32_bf16 v[16:19], v[44:47], a[48:51], 0
    v_mov_b32_dpp v29, v20 quad_perm:[0,0,0,0] row_mask:0xf bank_mask:0xf
    v_mfma_f32_16x16x32_bf16 v[16:19], v[48:51], a[52:55], v[16:19]
    v_mov_b32_dpp v14, v22 quad_perm:[2,2,2,2] row_mask:0xf bank_mask:0xf
    v_mfma_f32_16x16x32_bf16 v[16:19], v[52:55], a[56:59], v[16:19]
    v_add_f32_dpp v29, v21, v29 quad_perm:[1,1,1,1] row_mask:0xf bank_mask:0xf
    buffer_load_dwordx4 v[92:95], v9, s[16:19], s67 offen offset:2560
    v_mfma_f32_16x16x32_bf16 v[16:19], v[56:59], a[60:63], v[16:19]
    v_add_f32_dpp v14, v23, v14 quad_perm:[3,3,3,3] row_mask:0xf bank_mask:0xf
    v_add_f32 v29, v29, v14
    v_mfma_f32_16x16x32_bf16 v[20:23], v[44:47], a[64:67], 0
    v_mov_b32_dpp v30, v24 quad_perm:[0,0,0,0] row_mask:0xf bank_mask:0xf
    v_mfma_f32_16x16x32_bf16 v[20:23], v[48:51], a[68:71], v[20:23]
    v_mov_b32_dpp v14, v26 quad_perm:[2,2,2,2] row_mask:0xf bank_mask:0xf
    v_mfma_f32_16x16x32_bf16 v[20:23], v[52:55], a[72:75], v[20:23]
    v_add_f32_dpp v30, v25, v30 quad_perm:[1,1,1,1] row_mask:0xf bank_mask:0xf
    v_mfma_f32_16x16x32_bf16 v[20:23], v[56:59], a[76:79], v[20:23]
    v_add_f32_dpp v14, v27, v14 quad_perm:[3,3,3,3] row_mask:0xf bank_mask:0xf
    v_add_f32 v30, v30, v14
    v_mfma_f32_16x16x32_bf16 v[24:27], v[44:47], a[80:83], 0
    v_mov_b32_dpp v31, v16 quad_perm:[0,0,0,0] row_mask:0xf bank_mask:0xf
    v_mfma_f32_16x16x32_bf16 v[24:27], v[48:51], a[84:87], v[24:27]
    v_mov_b32_dpp v14, v18 quad_perm:[2,2,2,2] row_mask:0xf bank_mask:0xf
    v_mfma_f32_16x16x32_bf16 v[24:27], v[52:55], a[88:91], v[24:27]
    v_add_f32_dpp v31, v17, v31 quad_perm:[1,1,1,1] row_mask:0xf bank_mask:0xf
    v_mfma_f32_16x16x32_bf16 v[24:27], v[56:59], a[92:95], v[24:27]
    v_add_f32_dpp v14, v19, v14 quad_perm:[3,3,3,3] row_mask:0xf bank_mask:0xf
    v_add_f32 v31, v31, v14
    s_cmp_eq_u32 s7, 0
    s_cbranch_scc1 tu_102
    s_getreg_b32 s75, hwreg(HW_REG_IB_STS)
    s_bfe_u32 s94, s75, 0x20016
    s_and_b32 s75, s75, 15
    s_lshl4_add_u32 s75, s94, s75
    s_cmp_ge_u32 s75, 16
    s_cbranch_scc1 tu_102
    s_swappc_b64 s[30:31], s[28:29]
tu_102:
    v_mfma_f32_16x16x32_bf16 v[16:19], v[44:47], a[96:99], 0
    v_mov_b32_dpp v32, v20 quad_perm:[0,0,0,0] row_mask:0xf bank_mask:0xf
    v_mfma_f32_16x16x32_bf16 v[16:19], v[48:51], a[100:103], v[16:19]
    v_mov_b32_dpp v14, v22 quad_perm:[2,2,2,2] row_mask:0xf bank_mask:0xf
    v_mfma_f32_16x16x32_bf16 v[16:19], v[52:55], a[104:107], v[16:19]
    v_add_f32_dpp v32, v21, v32 quad_perm:[1,1,1,1] row_mask:0xf bank_mask:0xf
    v_mfma_f32_16x16x32_bf16 v[16:19], v[56:59], a[108:111], v[16:19]
    v_add_f32_dpp v14, v23, v14 quad_perm:[3,3,3,3] row_mask:0xf bank_mask:0xf
    v_add_f32 v32, v32, v14
    v_mfma_f32_16x16x32_bf16 v[20:23], v[44:47], a[112:115], 0
    v_mov_b32_dpp v33, v24 quad_perm:[0,0,0,0] row_mask:0xf bank_mask:0xf
    v_mfma_f32_16x16x32_bf16 v[20:23], v[48:51], a[116:119], v[20:23]
    v_mov_b32_dpp v14, v26 quad_perm:[2,2,2,2] row_mask:0xf bank_mask:0xf
    v_mfma_f32_16x16x32_bf16 v[20:23], v[52:55], a[120:123], v[20:23]
    v_add_f32_dpp v33, v25, v33 quad_perm:[1,1,1,1] row_mask:0xf bank_mask:0xf
    v_mfma_f32_16x16x32_bf16 v[20:23], v[56:59], a[124:127], v[20:23]
    v_add_f32_dpp v14, v27, v14 quad_perm:[3,3,3,3] row_mask:0xf bank_mask:0xf
    v_add_f32 v33, v33, v14
    v_mfma_f32_16x16x32_bf16 v[24:27], v[44:47], a[128:131], 0
    v_mov_b32_dpp v34, v16 quad_perm:[0,0,0,0] row_mask:0xf bank_mask:0xf
    v_mfma_f32_16x16x32_bf16 v[24:27], v[48:51], a[132:135], v[24:27]
    v_mov_b32_dpp v14, v18 quad_perm:[2,2,2,2] row_mask:0xf bank_mask:0xf
    v_mfma_f32_16x16x32_bf16 v[24:27], v[52:55], a[136:139], v[24:27]
    v_add_f32_dpp v34, v17, v34 quad_perm:[1,1,1,1] row_mask:0xf bank_mask:0xf
    v_mfma_f32_16x16x32_bf16 v[24:27], v[56:59], a[140:143], v[24:27]
    v_add_f32_dpp v14, v19, v14 quad_perm:[3,3,3,3] row_mask:0xf bank_mask:0xf
    v_add_f32 v34, v34, v14
    v_mfma_f32_16x16x32_bf16 v[16:19], v[44:47], a[144:147], 0
    v_mov_b32_dpp v35, v20 quad_perm:[0,0,0,0] row_mask:0xf bank_mask:0xf
    v_mfma_f32_16x16x32_bf16 v[16:19], v[48:51], a[148:151], v[16:19]
    v_mov_b32_dpp v14, v22 quad_perm:[2,2,2,2] row_mask:0xf bank_mask:0xf
    v_mfma_f32_16x16x32_bf16 v[16:19], v[52:55], a[152:155], v[16:19]
    v_add_f32_dpp v35, v21, v35 quad_perm:[1,1,1,1] row_mask:0xf bank_mask:0xf
    v_mfma_f32_16x16x32_bf16 v[16:19], v[56:59], a[156:159], v[16:19]
    v_add_f32_dpp v14, v23, v14 quad_perm:[3,3,3,3] row_mask:0xf bank_mask:0xf
    v_add_f32 v35, v35, v14
    s_cmp_eq_u32 s7, 0
    s_cbranch_scc1 tu_103
    s_getreg_b32 s75, hwreg(HW_REG_IB_STS)
    s_bfe_u32 s94, s75, 0x20016
    s_and_b32 s75, s75, 15
    s_lshl4_add_u32 s75, s94, s75
    s_cmp_ge_u32 s75, 16
    s_cbranch_scc1 tu_103
    s_swappc_b64 s[30:31], s[28:29]
tu_103:
    v_mfma_f32_16x16x32_bf16 v[20:23], v[44:47], a[160:163], 0
    v_mov_b32_dpp v36, v24 quad_perm:[0,0,0,0] row_mask:0xf bank_mask:0xf
    v_mfma_f32_16x16x32_bf16 v[20:23], v[48:51], a[164:167], v[20:23]
    v_mov_b32_dpp v14, v26 quad_perm:[2,2,2,2] row_mask:0xf bank_mask:0xf
    v_mfma_f32_16x16x32_bf16 v[20:23], v[52:55], a[168:171], v[20:23]
    v_add_f32_dpp v36, v25, v36 quad_perm:[1,1,1,1] row_mask:0xf bank_mask:0xf
    v_mfma_f32_16x16x32_bf16 v[20:23], v[56:59], a[172:175], v[20:23]
    v_add_f32_dpp v14, v27, v14 quad_perm:[3,3,3,3] row_mask:0xf bank_mask:0xf
    v_add_f32 v36, v36, v14
    v_mfma_f32_16x16x32_bf16 v[24:27], v[44:47], a[176:179], 0
    v_mov_b32_dpp v37, v16 quad_perm:[0,0,0,0] row_mask:0xf bank_mask:0xf
    v_mfma_f32_16x16x32_bf16 v[24:27], v[48:51], a[180:183], v[24:27]
    v_mov_b32_dpp v14, v18 quad_perm:[2,2,2,2] row_mask:0xf bank_mask:0xf
    v_mfma_f32_16x16x32_bf16 v[24:27], v[52:55], a[184:187], v[24:27]
    v_add_f32_dpp v37, v17, v37 quad_perm:[1,1,1,1] row_mask:0xf bank_mask:0xf
    v_mfma_f32_16x16x32_bf16 v[24:27], v[56:59], a[188:191], v[24:27]
    v_add_f32_dpp v14, v19, v14 quad_perm:[3,3,3,3] row_mask:0xf bank_mask:0xf
    v_add_f32 v37, v37, v14
    v_mfma_f32_16x16x32_bf16 v[16:19], v[44:47], a[192:195], 0
    v_mov_b32_dpp v38, v20 quad_perm:[0,0,0,0] row_mask:0xf bank_mask:0xf
    v_mfma_f32_16x16x32_bf16 v[16:19], v[48:51], a[196:199], v[16:19]
    v_mov_b32_dpp v14, v22 quad_perm:[2,2,2,2] row_mask:0xf bank_mask:0xf
    v_mfma_f32_16x16x32_bf16 v[16:19], v[52:55], a[200:203], v[16:19]
    v_add_f32_dpp v38, v21, v38 quad_perm:[1,1,1,1] row_mask:0xf bank_mask:0xf
    v_mfma_f32_16x16x32_bf16 v[16:19], v[56:59], a[204:207], v[16:19]
    v_add_f32_dpp v14, v23, v14 quad_perm:[3,3,3,3] row_mask:0xf bank_mask:0xf
    v_add_f32 v38, v38, v14
    v_mfma_f32_16x16x32_bf16 v[20:23], v[44:47], a[208:211], 0
    v_mov_b32_dpp v39, v24 quad_perm:[0,0,0,0] row_mask:0xf bank_mask:0xf
    v_mfma_f32_16x16x32_bf16 v[20:23], v[48:51], a[212:215], v[20:23]
    v_mov_b32_dpp v14, v26 quad_perm:[2,2,2,2] row_mask:0xf bank_mask:0xf
    v_mfma_f32_16x16x32_bf16 v[20:23], v[52:55], a[216:219], v[20:23]
    v_add_f32_dpp v39, v25, v39 quad_perm:[1,1,1,1] row_mask:0xf bank_mask:0xf
    v_mfma_f32_16x16x32_bf16 v[20:23], v[56:59], a[220:223], v[20:23]
    v_add_f32_dpp v14, v27, v14 quad_perm:[3,3,3,3] row_mask:0xf bank_mask:0xf
    v_add_f32 v39, v39, v14
    s_cmp_eq_u32 s7, 0
    s_cbranch_scc1 tu_104
    s_getreg_b32 s75, hwreg(HW_REG_IB_STS)
    s_bfe_u32 s94, s75, 0x20016
    s_and_b32 s75, s75, 15
    s_lshl4_add_u32 s75, s94, s75
    s_cmp_ge_u32 s75, 16
    s_cbranch_scc1 tu_104
    s_swappc_b64 s[30:31], s[28:29]
tu_104:
    v_mfma_f32_16x16x32_bf16 v[24:27], v[44:47], a[224:227], 0
    v_mov_b32_dpp v40, v16 quad_perm:[0,0,0,0] row_mask:0xf bank_mask:0xf
    v_mfma_f32_16x16x32_bf16 v[24:27], v[48:51], a[228:231], v[24:27]
    v_mov_b32_dpp v14, v18 quad_perm:[2,2,2,2] row_mask:0xf bank_mask:0xf
    v_mfma_f32_16x16x32_bf16 v[24:27], v[52:55], a[232:235], v[24:27]
    v_add_f32_dpp v40, v17, v40 quad_perm:[1,1,1,1] row_mask:0xf bank_mask:0xf
    v_mfma_f32_16x16x32_bf16 v[24:27], v[56:59], a[236:239], v[24:27]
    v_add_f32_dpp v14, v19, v14 quad_perm:[3,3,3,3] row_mask:0xf bank_mask:0xf
    v_add_f32 v40, v40, v14
    v_mfma_f32_16x16x32_bf16 v[16:19], v[44:47], a[240:243], 0
    v_mov_b32_dpp v41, v20 quad_perm:[0,0,0,0] row_mask:0xf bank_mask:0xf
    v_mfma_f32_16x16x32_bf16 v[16:19], v[48:51], a[244:247], v[16:19]
    v_mov_b32_dpp v14, v22 quad_perm:[2,2,2,2] row_mask:0xf bank_mask:0xf
    v_mfma_f32_16x16x32_bf16 v[16:19], v[52:55], a[248:251], v[16:19]
    v_add_f32_dpp v41, v21, v41 quad_perm:[1,1,1,1] row_mask:0xf bank_mask:0xf
    v_mfma_f32_16x16x32_bf16 v[16:19], v[56:59], a[252:255], v[16:19]
    v_add_f32_dpp v14, v23, v14 quad_perm:[3,3,3,3] row_mask:0xf bank_mask:0xf
    v_add_f32 v41, v41, v14
    v_mov_b32_dpp v42, v24 quad_perm:[0,0,0,0] row_mask:0xf bank_mask:0xf
    s_nop 4
    v_mov_b32_dpp v43, v16 quad_perm:[0,0,0,0] row_mask:0xf bank_mask:0xf
    v_mov_b32_dpp v14, v26 quad_perm:[2,2,2,2] row_mask:0xf bank_mask:0xf
    v_mov_b32_dpp v15, v18 quad_perm:[2,2,2,2] row_mask:0xf bank_mask:0xf
    v_add_f32_dpp v42, v25, v42 quad_perm:[1,1,1,1] row_mask:0xf bank_mask:0xf
    v_add_f32_dpp v43, v17, v43 quad_perm:[1,1,1,1] row_mask:0xf bank_mask:0xf
    v_add_f32_dpp v14, v27, v14 quad_perm:[3,3,3,3] row_mask:0xf bank_mask:0xf
    v_add_f32_dpp v15, v19, v15 quad_perm:[3,3,3,3] row_mask:0xf bank_mask:0xf
    v_add_f32 v42, v42, v14
    v_add_f32 v43, v43, v15
    v_max3_f32 v14, v28, v29, v30
    v_max3_f32 v15, v31, v32, v33
    v_max3_f32 v14, v14, v34, v35
    v_max3_f32 v15, v15, v36, v37
    v_max3_f32 v14, v14, v38, v39
    v_max3_f32 v15, v15, v40, v41
    v_max3_f32 v14, v14, v42, v43
    v_max_f32 v14, v14, v15
    s_nop 1
    v_max_f32_dpp v14, v14, v14 row_ror:4 row_mask:0xf bank_mask:0xf
    s_nop 1
    v_max_f32_dpp v14, v14, v14 row_ror:8 row_mask:0xf bank_mask:0xf
    s_nop 1
    v_max_f32_dpp v14, v14, v14 row_bcast:15 row_mask:0xa bank_mask:0xf
    s_nop 1
    v_max_f32_dpp v14, v14, v14 row_bcast:31 row_mask:0xc bank_mask:0xf
    s_nop 0
    v_readlane_b32 s90, v14, 63
    v_mov_b32 v15, s100
    s_nop 0
    v_mul_f32 v14, s90, v15
    s_nop 0
    v_readfirstlane_b32 s90, v14
    v_fma_f32 v28, v28, s100, -v14
    v_fma_f32 v29, v29, s100, -v14
    v_fma_f32 v30, v30, s100, -v14
    v_fma_f32 v31, v31, s100, -v14
    v_fma_f32 v32, v32, s100, -v14
    v_fma_f32 v33, v33, s100, -v14
    v_fma_f32 v34, v34, s100, -v14
    v_fma_f32 v35, v35, s100, -v14
    v_fma_f32 v36, v36, s100, -v14
    v_fma_f32 v37, v37, s100, -v14
    v_fma_f32 v38, v38, s100, -v14
    v_fma_f32 v39, v39, s100, -v14
    v_fma_f32 v40, v40, s100, -v14
    v_fma_f32 v41, v41, s100, -v14
    v_fma_f32 v42, v42, s100, -v14
    v_fma_f32 v43, v43, s100, -v14
    v_exp_f32 v28, v28
    v_exp_f32 v29, v29
    s_add_u32 m0, s66, 0
    s_mov_b32 s65, 0
    buffer_load_dwordx4 v13, s[20:23], s65 offen  lds
    v_exp_f32 v30, v30
    v_exp_f32 v31, v31
    s_add_u32 m0, s66, 960
    s_mov_b32 s65, 7680
    buffer_load_dwordx4 v13, s[20:23], s65 offen  lds
    v_exp_f32 v32, v32
    v_exp_f32 v33, v33
    s_add_u32 m0, s66, 1920
    s_mov_b32 s65, 15360
    buffer_load_dwordx4 v13, s[20:23], s65 offen  lds
    v_exp_f32 v34, v34
    v_exp_f32 v35, v35
    s_add_u32 m0, s66, 2880
    s_mov_b32 s65, 23040
    buffer_load_dwordx4 v13, s[20:23], s65 offen  lds
    v_exp_f32 v36, v36
    v_exp_f32 v37, v37
    s_add_u32 m0, s66, 3840
    s_mov_b32 s65, 30720
    buffer_load_dwordx4 v13, s[20:23], s65 offen  lds
    v_exp_f32 v38, v38
    v_exp_f32 v39, v39
    s_add_u32 m0, s66, 4160
    s_mov_b32 s65, 33280
    buffer_load_dwordx4 v13, s[20:23], s65 offen  lds
    v_exp_f32 v40, v40
    v_exp_f32 v41, v41
    v_exp_f32 v42, v42
    v_exp_f32 v43, v43
    v_add_f32 v14, v28, v29
    v_add_f32 v15, v30, v31
    v_add_f32 v14, v14, v32
    v_add_f32 v15, v15, v33
    v_add_f32 v14, v14, v34
    v_add_f32 v15, v15, v35
    v_add_f32 v14, v14, v36
    v_add_f32 v15, v15, v37
    v_add_f32 v14, v14, v38
    v_add_f32 v15, v15, v39
    v_add_f32 v14, v14, v40
    v_add_f32 v15, v15, v41
    v_add_f32 v14, v14, v42
    v_add_f32 v15, v15, v43
    v_add_f32 v14, v14, v15
    v_cvt_pk_bf16_f32 v28, v28, v28
    v_cvt_pk_bf16_f32 v29, v29, v29
    v_add_f32_dpp v14, v14, v14 row_ror:4 row_mask:0xf bank_mask:0xf
    v_cvt_pk_bf16_f32 v30, v30, v30
    v_cvt_pk_bf16_f32 v31, v31, v31
    v_cvt_pk_bf16_f32 v32, v32, v32
    v_cvt_pk_bf16_f32 v33, v33, v33
    v_add_f32_dpp v14, v14, v14 row_ror:8 row_mask:0xf bank_mask:0xf
    v_cvt_pk_bf16_f32 v34, v34, v34
    v_cvt_pk_bf16_f32 v35, v35, v35
    v_cvt_pk_bf16_f32 v36, v36, v36
    v_cvt_pk_bf16_f32 v37, v37, v37
    v_add_f32_dpp v14, v14, v14 row_bcast:15 row_mask:0xa bank_mask:0xf
    v_cvt_pk_bf16_f32 v38, v38, v38
    v_cvt_pk_bf16_f32 v39, v39, v39
    v_cvt_pk_bf16_f32 v40, v40, v40
    v_cvt_pk_bf16_f32 v41, v41, v41
    v_add_f32_dpp v14, v14, v14 row_bcast:31 row_mask:0xc bank_mask:0xf
    v_cvt_pk_bf16_f32 v42, v42, v42
    v_cvt_pk_bf16_f32 v43, v43, v43
    v_readlane_b32 s91, v14, 63
drain_105:
    s_cmp_eq_u32 s7, 0
    s_cbranch_scc1 drained_106
    s_swappc_b64 s[30:31], s[28:29]
    s_waitcnt vmcnt(16)
    s_branch drain_105
drained_106:
    s_waitcnt vmcnt(16)
    s_lshl_b32 s65, s5, 14
    v_add_u32 v15, s65, v0
    v_bfe_u32 v14, v0, 4, 4
    v_and_b32 v58, 3, v14
    v_mul_u32_u24 v58, 0x1111, v58
    v_lshrrev_b32 v14, 2, v14
    v_mov_b32 v59, 0xffff
    v_cmp_eq_u32 vcc, 0, v14
    s_nop 1
    v_cndmask_b32 v56, 0, v59, vcc
    v_cmp_eq_u32 vcc, 1, v14
    s_nop 1
    v_cndmask_b32 v57, 0, v59, vcc
    v_mov_b32 v52, 0
    v_mov_b32 v53, 0
    v_mov_b32 v54, 0
    v_mov_b32 v55, 0
    v_and_b32_dpp v44, v28, v56 row_newbcast:0 row_mask:0xf bank_mask:0xf
    v_and_b32_dpp v45, v28, v57 row_newbcast:0 row_mask:0xf bank_mask:0xf
    v_and_b32_dpp v46, v28, v56 row_newbcast:4 row_mask:0xf bank_mask:0xf
    v_and_b32_dpp v47, v28, v57 row_newbcast:4 row_mask:0xf bank_mask:0xf
    v_and_b32_dpp v48, v28, v56 row_newbcast:8 row_mask:0xf bank_mask:0xf
    v_and_b32_dpp v49, v28, v57 row_newbcast:8 row_mask:0xf bank_mask:0xf
    v_and_b32_dpp v50, v28, v56 row_newbcast:12 row_mask:0xf bank_mask:0xf
    v_and_b32_dpp v51, v28, v57 row_newbcast:12 row_mask:0xf bank_mask:0xf
    v_smfmac_f32_16x16x64_bf16 v[52:55], v[44:47], v[96:103], v58
    v_and_b32_dpp v44, v29, v56 row_newbcast:0 row_mask:0xf bank_mask:0xf
    v_and_b32_dpp v45, v29, v57 row_newbcast:0 row_mask:0xf bank_mask:0xf
    v_and_b32_dpp v46, v29, v56 row_newbcast:4 row_mask:0xf bank_mask:0xf
    v_and_b32_dpp v47, v29, v57 row_newbcast:4 row_mask:0xf bank_mask:0xf
    v_smfmac_f32_16x16x64_bf16 v[52:55], v[48:51], v[104:111], v58
    v_and_b32_dpp v48, v29, v56 row_newbcast:8 row_mask:0xf bank_mask:0xf
    v_and_b32_dpp v49, v29, v57 row_newbcast:8 row_mask:0xf bank_mask:0xf
    v_and_b32_dpp v50, v29, v56 row_newbcast:12 row_mask:0xf bank_mask:0xf
    v_and_b32_dpp v51, v29, v57 row_newbcast:12 row_mask:0xf bank_mask:0xf
    v_smfmac_f32_16x16x64_bf16 v[52:55], v[44:47], v[112:119], v58
    v_and_b32_dpp v44, v30, v56 row_newbcast:0 row_mask:0xf bank_mask:0xf
    v_and_b32_dpp v45, v30, v57 row_newbcast:0 row_mask:0xf bank_mask:0xf
    v_and_b32_dpp v46, v30, v56 row_newbcast:4 row_mask:0xf bank_mask:0xf
    v_and_b32_dpp v47, v30, v57 row_newbcast:4 row_mask:0xf bank_mask:0xf
    v_smfmac_f32_16x16x64_bf16 v[52:55], v[48:51], v[120:127], v58
    v_and_b32_dpp v48, v30, v56 row_newbcast:8 row_mask:0xf bank_mask:0xf
    v_and_b32_dpp v49, v30, v57 row_newbcast:8 row_mask:0xf bank_mask:0xf
    v_and_b32_dpp v50, v30, v56 row_newbcast:12 row_mask:0xf bank_mask:0xf
    v_and_b32_dpp v51, v30, v57 row_newbcast:12 row_mask:0xf bank_mask:0xf
    v_smfmac_f32_16x16x64_bf16 v[52:55], v[44:47], v[128:135], v58
    v_and_b32_dpp v44, v31, v56 row_newbcast:0 row_mask:0xf bank_mask:0xf
    v_and_b32_dpp v45, v31, v57 row_newbcast:0 row_mask:0xf bank_mask:0xf
    v_and_b32_dpp v46, v31, v56 row_newbcast:4 row_mask:0xf bank_mask:0xf
    v_and_b32_dpp v47, v31, v57 row_newbcast:4 row_mask:0xf bank_mask:0xf
    v_smfmac_f32_16x16x64_bf16 v[52:55], v[48:51], v[136:143], v58
    v_and_b32_dpp v48, v31, v56 row_newbcast:8 row_mask:0xf bank_mask:0xf
    v_and_b32_dpp v49, v31, v57 row_newbcast:8 row_mask:0xf bank_mask:0xf
    v_and_b32_dpp v50, v31, v56 row_newbcast:12 row_mask:0xf bank_mask:0xf
    v_and_b32_dpp v51, v31, v57 row_newbcast:12 row_mask:0xf bank_mask:0xf
    v_smfmac_f32_16x16x64_bf16 v[52:55], v[44:47], v[144:151], v58
    v_and_b32_dpp v44, v32, v56 row_newbcast:0 row_mask:0xf bank_mask:0xf
    v_and_b32_dpp v45, v32, v57 row_newbcast:0 row_mask:0xf bank_mask:0xf
    v_and_b32_dpp v46, v32, v56 row_newbcast:4 row_mask:0xf bank_mask:0xf
    v_and_b32_dpp v47, v32, v57 row_newbcast:4 row_mask:0xf bank_mask:0xf
    v_smfmac_f32_16x16x64_bf16 v[52:55], v[48:51], v[152:159], v58
    v_and_b32_dpp v48, v32, v56 row_newbcast:8 row_mask:0xf bank_mask:0xf
    v_and_b32_dpp v49, v32, v57 row_newbcast:8 row_mask:0xf bank_mask:0xf
    v_and_b32_dpp v50, v32, v56 row_newbcast:12 row_mask:0xf bank_mask:0xf
    v_and_b32_dpp v51, v32, v57 row_newbcast:12 row_mask:0xf bank_mask:0xf
    v_smfmac_f32_16x16x64_bf16 v[52:55], v[44:47], v[160:167], v58
    v_and_b32_dpp v44, v33, v56 row_newbcast:0 row_mask:0xf bank_mask:0xf
    v_and_b32_dpp v45, v33, v57 row_newbcast:0 row_mask:0xf bank_mask:0xf
    v_and_b32_dpp v46, v33, v56 row_newbcast:4 row_mask:0xf bank_mask:0xf
    v_and_b32_dpp v47, v33, v57 row_newbcast:4 row_mask:0xf bank_mask:0xf
    v_smfmac_f32_16x16x64_bf16 v[52:55], v[48:51], v[168:175], v58
    v_and_b32_dpp v48, v33, v56 row_newbcast:8 row_mask:0xf bank_mask:0xf
    v_and_b32_dpp v49, v33, v57 row_newbcast:8 row_mask:0xf bank_mask:0xf
    v_and_b32_dpp v50, v33, v56 row_newbcast:12 row_mask:0xf bank_mask:0xf
    v_and_b32_dpp v51, v33, v57 row_newbcast:12 row_mask:0xf bank_mask:0xf
    v_smfmac_f32_16x16x64_bf16 v[52:55], v[44:47], v[176:183], v58
    v_and_b32_dpp v44, v34, v56 row_newbcast:0 row_mask:0xf bank_mask:0xf
    v_and_b32_dpp v45, v34, v57 row_newbcast:0 row_mask:0xf bank_mask:0xf
    v_and_b32_dpp v46, v34, v56 row_newbcast:4 row_mask:0xf bank_mask:0xf
    v_and_b32_dpp v47, v34, v57 row_newbcast:4 row_mask:0xf bank_mask:0xf
    v_smfmac_f32_16x16x64_bf16 v[52:55], v[48:51], v[184:191], v58
    v_and_b32_dpp v48, v34, v56 row_newbcast:8 row_mask:0xf bank_mask:0xf
    v_and_b32_dpp v49, v34, v57 row_newbcast:8 row_mask:0xf bank_mask:0xf
    v_and_b32_dpp v50, v34, v56 row_newbcast:12 row_mask:0xf bank_mask:0xf
    v_and_b32_dpp v51, v34, v57 row_newbcast:12 row_mask:0xf bank_mask:0xf
    v_smfmac_f32_16x16x64_bf16 v[52:55], v[44:47], v[192:199], v58
    v_and_b32_dpp v44, v35, v56 row_newbcast:0 row_mask:0xf bank_mask:0xf
    v_and_b32_dpp v45, v35, v57 row_newbcast:0 row_mask:0xf bank_mask:0xf
    v_and_b32_dpp v46, v35, v56 row_newbcast:4 row_mask:0xf bank_mask:0xf
    v_and_b32_dpp v47, v35, v57 row_newbcast:4 row_mask:0xf bank_mask:0xf
    v_smfmac_f32_16x16x64_bf16 v[52:55], v[48:51], v[200:207], v58
    v_and_b32_dpp v48, v35, v56 row_newbcast:8 row_mask:0xf bank_mask:0xf
    v_and_b32_dpp v49, v35, v57 row_newbcast:8 row_mask:0xf bank_mask:0xf
    v_and_b32_dpp v50, v35, v56 row_newbcast:12 row_mask:0xf bank_mask:0xf
    v_and_b32_dpp v51, v35, v57 row_newbcast:12 row_mask:0xf bank_mask:0xf
    v_smfmac_f32_16x16x64_bf16 v[52:55], v[44:47], v[208:215], v58
    v_and_b32_dpp v44, v36, v56 row_newbcast:0 row_mask:0xf bank_mask:0xf
    v_and_b32_dpp v45, v36, v57 row_newbcast:0 row_mask:0xf bank_mask:0xf
    v_and_b32_dpp v46, v36, v56 row_newbcast:4 row_mask:0xf bank_mask:0xf
    v_and_b32_dpp v47, v36, v57 row_newbcast:4 row_mask:0xf bank_mask:0xf
    v_smfmac_f32_16x16x64_bf16 v[52:55], v[48:51], v[216:223], v58
    v_and_b32_dpp v48, v36, v56 row_newbcast:8 row_mask:0xf bank_mask:0xf
    v_and_b32_dpp v49, v36, v57 row_newbcast:8 row_mask:0xf bank_mask:0xf
    v_and_b32_dpp v50, v36, v56 row_newbcast:12 row_mask:0xf bank_mask:0xf
    v_and_b32_dpp v51, v36, v57 row_newbcast:12 row_mask:0xf bank_mask:0xf
    s_cmp_ge_u32 s6, 2
    s_cbranch_scc1 pw_107
    s_waitcnt vmcnt(0)
    s_branch pw_108
pw_107:
    s_waitcnt vmcnt(6)
pw_108:
    ds_read_b128 v[16:19], v15 offset:0
    ds_read_b128 v[20:23], v15 offset:1024
    ds_read_b128 v[28:31], v15 offset:2048
    ds_read_b128 v[32:35], v15 offset:3072
    v_smfmac_f32_16x16x64_bf16 v[52:55], v[44:47], v[224:231], v58
    v_and_b32_dpp v44, v37, v56 row_newbcast:0 row_mask:0xf bank_mask:0xf
    v_and_b32_dpp v45, v37, v57 row_newbcast:0 row_mask:0xf bank_mask:0xf
    v_and_b32_dpp v46, v37, v56 row_newbcast:4 row_mask:0xf bank_mask:0xf
    v_and_b32_dpp v47, v37, v57 row_newbcast:4 row_mask:0xf bank_mask:0xf
    v_smfmac_f32_16x16x64_bf16 v[52:55], v[48:51], v[232:239], v58
    v_and_b32_dpp v48, v37, v56 row_newbcast:8 row_mask:0xf bank_mask:0xf
    v_and_b32_dpp v49, v37, v57 row_newbcast:8 row_mask:0xf bank_mask:0xf
    v_and_b32_dpp v50, v37, v56 row_newbcast:12 row_mask:0xf bank_mask:0xf
    v_and_b32_dpp v51, v37, v57 row_newbcast:12 row_mask:0xf bank_mask:0xf
    v_smfmac_f32_16x16x64_bf16 v[52:55], v[44:47], v[240:247], v58
    v_and_b32_dpp v44, v38, v56 row_newbcast:0 row_mask:0xf bank_mask:0xf
    v_and_b32_dpp v45, v38, v57 row_newbcast:0 row_mask:0xf bank_mask:0xf
    v_and_b32_dpp v46, v38, v56 row_newbcast:4 row_mask:0xf bank_mask:0xf
    v_and_b32_dpp v47, v38, v57 row_newbcast:4 row_mask:0xf bank_mask:0xf
    v_smfmac_f32_16x16x64_bf16 v[52:55], v[48:51], v[248:255], v58
    v_and_b32_dpp v48, v38, v56 row_newbcast:8 row_mask:0xf bank_mask:0xf
    v_and_b32_dpp v49, v38, v57 row_newbcast:8 row_mask:0xf bank_mask:0xf
    v_and_b32_dpp v50, v38, v56 row_newbcast:12 row_mask:0xf bank_mask:0xf
    v_and_b32_dpp v51, v38, v57 row_newbcast:12 row_mask:0xf bank_mask:0xf
    s_waitcnt lgkmcnt(2)
    v_smfmac_f32_16x16x64_bf16 v[52:55], v[44:47], v[16:23], v58
    ds_read_b128 v[16:19], v15 offset:4096
    ds_read_b128 v[20:23], v15 offset:5120
    v_and_b32_dpp v44, v39, v56 row_newbcast:0 row_mask:0xf bank_mask:0xf
    v_and_b32_dpp v45, v39, v57 row_newbcast:0 row_mask:0xf bank_mask:0xf
    v_and_b32_dpp v46, v39, v56 row_newbcast:4 row_mask:0xf bank_mask:0xf
    v_and_b32_dpp v47, v39, v57 row_newbcast:4 row_mask:0xf bank_mask:0xf
    s_waitcnt lgkmcnt(2)
    v_smfmac_f32_16x16x64_bf16 v[52:55], v[48:51], v[28:35], v58
    ds_read_b128 v[28:31], v15 offset:6144
    ds_read_b128 v[32:35], v15 offset:7168
    v_and_b32_dpp v48, v39, v56 row_newbcast:8 row_mask:0xf bank_mask:0xf
    v_and_b32_dpp v49, v39, v57 row_newbcast:8 row_mask:0xf bank_mask:0xf
    v_and_b32_dpp v50, v39, v56 row_newbcast:12 row_mask:0xf bank_mask:0xf
    v_and_b32_dpp v51, v39, v57 row_newbcast:12 row_mask:0xf bank_mask:0xf
    s_waitcnt lgkmcnt(2)
    v_smfmac_f32_16x16x64_bf16 v[52:55], v[44:47], v[16:23], v58
    ds_read_b128 v[16:19], v15 offset:8192
    ds_read_b128 v[20:23], v15 offset:9216
    v_and_b32_dpp v44, v40, v56 row_newbcast:0 row_mask:0xf bank_mask:0xf
    v_and_b32_dpp v45, v40, v57 row_newbcast:0 row_mask:0xf bank_mask:0xf
    v_and_b32_dpp v46, v40, v56 row_newbcast:4 row_mask:0xf bank_mask:0xf
    v_and_b32_dpp v47, v40, v57 row_newbcast:4 row_mask:0xf bank_mask:0xf
    s_waitcnt lgkmcnt(2)
    v_smfmac_f32_16x16x64_bf16 v[52:55], v[48:51], v[28:35], v58
    ds_read_b128 v[28:31], v15 offset:10240
    ds_read_b128 v[32:35], v15 offset:11264
    v_and_b32_dpp v48, v40, v56 row_newbcast:8 row_mask:0xf bank_mask:0xf
    v_and_b32_dpp v49, v40, v57 row_newbcast:8 row_mask:0xf bank_mask:0xf
    v_and_b32_dpp v50, v40, v56 row_newbcast:12 row_mask:0xf bank_mask:0xf
    v_and_b32_dpp v51, v40, v57 row_newbcast:12 row_mask:0xf bank_mask:0xf
    s_waitcnt lgkmcnt(2)
    v_smfmac_f32_16x16x64_bf16 v[52:55], v[44:47], v[16:23], v58
    ds_read_b128 v[16:19], v15 offset:12288
    ds_read_b128 v[20:23], v15 offset:13312
    v_and_b32_dpp v44, v41, v56 row_newbcast:0 row_mask:0xf bank_mask:0xf
    v_and_b32_dpp v45, v41, v57 row_newbcast:0 row_mask:0xf bank_mask:0xf
    v_and_b32_dpp v46, v41, v56 row_newbcast:4 row_mask:0xf bank_mask:0xf
    v_and_b32_dpp v47, v41, v57 row_newbcast:4 row_mask:0xf bank_mask:0xf
    s_waitcnt lgkmcnt(2)
    v_smfmac_f32_16x16x64_bf16 v[52:55], v[48:51], v[28:35], v58
    ds_read_b128 v[28:31], v15 offset:14336
    ds_read_b128 v[32:35], v15 offset:15360
    v_and_b32_dpp v48, v41, v56 row_newbcast:8 row_mask:0xf bank_mask:0xf
    v_and_b32_dpp v49, v41, v57 row_newbcast:8 row_mask:0xf bank_mask:0xf
    v_and_b32_dpp v50, v41, v56 row_newbcast:12 row_mask:0xf bank_mask:0xf
    v_and_b32_dpp v51, v41, v57 row_newbcast:12 row_mask:0xf bank_mask:0xf
    s_waitcnt lgkmcnt(2)
    v_smfmac_f32_16x16x64_bf16 v[52:55], v[44:47], v[16:23], v58
    v_and_b32_dpp v44, v42, v56 row_newbcast:0 row_mask:0xf bank_mask:0xf
    v_and_b32_dpp v45, v42, v57 row_newbcast:0 row_mask:0xf bank_mask:0xf
    v_and_b32_dpp v46, v42, v56 row_newbcast:4 row_mask:0xf bank_mask:0xf
    v_and_b32_dpp v47, v42, v57 row_newbcast:4 row_mask:0xf bank_mask:0xf
    s_waitcnt lgkmcnt(0)
    v_smfmac_f32_16x16x64_bf16 v[52:55], v[48:51], v[28:35], v58
    v_and_b32_dpp v48, v42, v56 row_newbcast:8 row_mask:0xf bank_mask:0xf
    v_and_b32_dpp v49, v42, v57 row_newbcast:8 row_mask:0xf bank_mask:0xf
    v_and_b32_dpp v50, v42, v56 row_newbcast:12 row_mask:0xf bank_mask:0xf
    v_and_b32_dpp v51, v42, v57 row_newbcast:12 row_mask:0xf bank_mask:0xf
    v_smfmac_f32_16x16x64_bf16 v[52:55], v[44:47], v[60:67], v58
    v_and_b32_dpp v44, v43, v56 row_newbcast:0 row_mask:0xf bank_mask:0xf
    v_and_b32_dpp v45, v43, v57 row_newbcast:0 row_mask:0xf bank_mask:0xf
    v_and_b32_dpp v46, v43, v56 row_newbcast:4 row_mask:0xf bank_mask:0xf
    v_and_b32_dpp v47, v43, v57 row_newbcast:4 row_mask:0xf bank_mask:0xf
    v_smfmac_f32_16x16x64_bf16 v[52:55], v[48:51], v[68:75], v58
    v_and_b32_dpp v48, v43, v56 row_newbcast:8 row_mask:0xf bank_mask:0xf
    v_and_b32_dpp v49, v43, v57 row_newbcast:8 row_mask:0xf bank_mask:0xf
    v_and_b32_dpp v50, v43, v56 row_newbcast:12 row_mask:0xf bank_mask:0xf
    v_and_b32_dpp v51, v43, v57 row_newbcast:12 row_mask:0xf bank_mask:0xf
    v_smfmac_f32_16x16x64_bf16 v[52:55], v[44:47], v[80:87], v58
    s_nop 0
    v_smfmac_f32_16x16x64_bf16 v[52:55], v[48:51], v[88:95], v58
    s_lshl_b32 s65, s3, 3
    s_add_u32 s65, s65, s4
    s_lshl_b32 s65, s65, 10
    s_add_u32 s65, s65, 1572864
    s_nop 3
    v_writelane_b32 v52, s90, 32
    v_writelane_b32 v53, s91, 32
    s_mov_b32 exec_hi, 1
    ds_write_b128 v10, v[52:55] offset:0
    s_mov_b32 exec_hi, -1
    s_waitcnt lgkmcnt(0)
    s_barrier
    s_cmp_lg_u32 s5, 0
    s_cbranch_scc1 bfin_109
    v_mov_b32 v14, 156672
    ds_read_b64 v[32:33], v14 offset:0
    ds_read_b64 v[34:35], v14 offset:1056
    ds_read_b64 v[36:37], v14 offset:2112
    ds_read_b64 v[38:39], v14 offset:3168
    v_add_u32 v11, 156160, v0
    ds_read_b128 v[16:19], v11 offset:0
    ds_read_b128 v[20:23], v11 offset:1056
    ds_read_b128 v[24:27], v11 offset:2112
    ds_read_b128 v[28:31], v11 offset:3168
    s_waitcnt lgkmcnt(4)
    v_max3_f32 v40, v32, v34, v36
    v_max_f32 v40, v40, v38
    v_sub_f32 v32, v32, v40
    v_sub_f32 v34, v34, v40
    v_sub_f32 v36, v36, v40
    v_sub_f32 v38, v38, v40
    v_exp_f32 v32, v32
    v_exp_f32 v34, v34
    v_exp_f32 v36, v36
    v_exp_f32 v38, v38
    v_readfirstlane_b32 s90, v40
    s_waitcnt lgkmcnt(0)
    v_mul_f32 v16, v32, v16
    v_mul_f32 v17, v32, v17
    v_mul_f32 v18, v32, v18
    v_mul_f32 v19, v32, v19
    v_fmac_f32 v16, v34, v20
    v_fmac_f32 v17, v34, v21
    v_fmac_f32 v18, v34, v22
    v_fmac_f32 v19, v34, v23
    v_fmac_f32 v16, v36, v24
    v_fmac_f32 v17, v36, v25
    v_fmac_f32 v18, v36, v26
    v_fmac_f32 v19, v36, v27
    v_fmac_f32 v16, v38, v28
    v_fmac_f32 v17, v38, v29
    v_fmac_f32 v18, v38, v30
    v_fmac_f32 v19, v38, v31
    v_writelane_b32 v16, s90, 32
    v_perm_b32 v16, v16, v5, s36
    v_perm_b32 v17, v17, v5, s37
    v_perm_b32 v18, v18, v5, s38
    v_perm_b32 v19, v19, v5, s39
    s_mov_b32 exec_hi, 1
    s_cmp_eq_u32 s89, 0
    s_cbranch_scc1 ls_110
    buffer_store_dwordx4 v[16:19], v0, s[8:11], s65 offen
    s_branch ls_111
ls_110:
    buffer_store_dwordx4 v[16:19], v0, s[8:11], s65 offen sc1
ls_111:
    s_mov_b32 exec_hi, -1
bfin_109:
L_opart:
    v_lshrrev_b32 v14, 7, v0
    v_lshlrev_b32 v15, 10, v14
    v_and_b32 v14, 0x70, v0
    v_add_u32 v14, v15, v14
    s_lshl_b32 s65, s3, 13
    s_add_u32 s65, s65, 1572864
    s_lshl_b32 s66, s5, 7
    s_add_u32 s66, s66, s65
    v_lshrrev_b32 v59, 8, v0
    v_and_b32 v58, 1, v59
    v_lshrrev_b32 v59, 1, v59
    v_lshl_add_u32 v59, v58, 2, v59
    v_mul_u32_u24 v59, 160, v59
    v_bfe_u32 v57, v0, 4, 4
    v_and_b32 v62, 3, v57
    v_mul_u32_u24 v62, 0x1111, v62
    v_lshrrev_b32 v57, 2, v57
    v_cmp_eq_u32 vcc, 0, v57
    v_mov_b32 v61, 0xffff
    s_nop 0
    v_cndmask_b32 v60, 0, v61, vcc
    v_cmp_eq_u32 vcc, 1, v57
    s_nop 1
    v_cndmask_b32 v61, 0, v61, vcc
    v_and_b32 v58, 0xf0, v0
    v_add_u32 v59, v59, v58
    s_mul_i32 s67, s5, 5184
    s_add_u32 s67, s67, 131072
    v_add_u32 v59, s67, v59
    v_lshrrev_b32 v63, 4, v0
    v_mul_u32_u24 v58, 13108, v63
    v_lshrrev_b32 v58, 16, v58
    v_mul_u32_u24 v57, 5, v58
    v_sub_u32 v63, v63, v57
    v_lshlrev_b32 v63, 4, v63
    v_lshl_add_u32 v63, v58, 7, v63
    s_lshl_b32 s69, s4, 5
    s_add_u32 s69, s69, s3
    s_lshl_b32 s69, s69, 9
    s_add_u32 s69, s69, s58
    s_mov_b32 s62, 0
    s_cmp_ge_u32 s6, 1
    s_cbranch_scc1 pd_116
    s_cmp_eq_u32 s7, 0
    s_cbranch_scc1 dwn_118
    s_mov_b32 s74, 0
    s_mov_b32 s95, 20
    s_mov_b32 s0, 102
    s_swappc_b64 s[72:73], s[70:71]
    s_branch dwj_119
dwn_118:
    s_waitcnt vmcnt(0)
dwj_119:
    s_barrier
    s_branch pd_117
pd_116:
    s_sleep 2
pd_117:
poll_112:
    buffer_load_dwordx4 v[20:23], v15, s[8:11], s65 offen offset:512 sc1
    buffer_load_dwordx4 v[16:19], v14, s[8:11], s66 offen sc1
    s_cmp_eq_u32 s7, 0
    s_cbranch_scc1 dwn_120
    s_mov_b32 s74, 0
    s_mov_b32 s95, 22
    s_mov_b32 s0, 102
    s_swappc_b64 s[72:73], s[70:71]
    s_branch dwj_121
dwn_120:
    s_waitcnt vmcnt(0)
dwj_121:
pj_114:
    v_xor_b32 v20, s32, v20
    v_xor_b32 v21, s33, v21
    v_xor_b32 v22, s34, v22
    v_xor_b32 v23, s35, v23
    v_xor_b32 v16, s32, v16
    v_xor_b32 v17, s33, v17
    v_xor_b32 v18, s34, v18
    v_xor_b32 v19, s35, v19
    v_or3_b32 v11, v20, v21, v22
    v_or3_b32 v12, v23, v16, v17
    v_or3_b32 v11, v11, v18, v19
    v_or_b32 v11, v11, v12
    v_and_b32 v11, s64, v11
    v_cmp_ne_u32 vcc, 0, v11
    s_cbranch_vccz pdone_115
    s_add_u32 s62, s62, 1
    s_cmp_lt_u32 s62, 65536
    s_cbranch_scc1 poll_112
    s_mov_b32 s88, 1
pdone_115:
    ds_read_b128 v[24:27], v59 offset:0
    ds_read_b128 v[28:31], v59 offset:320
    ds_read_b128 v[32:35], v59 offset:1280
    ds_read_b128 v[36:39], v59 offset:1600
    ds_read_b128 v[40:43], v59 offset:2560
    ds_read_b128 v[44:47], v59 offset:2880
    ds_read_b128 v[48:51], v59 offset:3840
    ds_read_b128 v[52:55], v59 offset:4160
    s_cmp_eq_u32 s6, 3
    s_cbranch_scc1 nopf_122
    s_add_u32 s6, s6, 1
    s_bitcmp1_b32 s6, 0
    s_cbranch_scc1 wq_124
    s_mov_b32 s20, s40
    s_mov_b32 s21, s41
    s_branch wq_125
wq_124:
    s_mov_b32 s20, s42
    s_mov_b32 s21, s43
wq_125:
    s_mov_b32 s22, 155904
    s_mov_b32 s23, 0x20000
    s_mov_b32 s65, 0
    buffer_load_dwordx4 v[76:79], v7, s[20:23], s65 offen
    s_mov_b32 s65, 32768
    buffer_load_dwordx4 v[80:83], v7, s[20:23], s65 offen
    s_mov_b32 s65, 65536
    buffer_load_dwordx4 v[84:87], v7, s[20:23], s65 offen
    s_mov_b32 s65, 98304
    buffer_load_dwordx4 v[88:91], v7, s[20:23], s65 offen
    s_mov_b32 s65, 131072
    buffer_load_dwordx4 v[92:95], v7, s[20:23], s65 offen
    s_sub_u32 s6, s6, 1
nopf_122:
    v_max_f32_dpp v56, v20, v20 row_ror:8 row_mask:0xf bank_mask:0xf
    s_nop 1
    v_max_f32_dpp v56, v56, v56 row_bcast:15 row_mask:0xa bank_mask:0xf
    s_nop 1
    v_max_f32_dpp v56, v56, v56 row_bcast:31 row_mask:0xc bank_mask:0xf
    s_nop 0
    v_readlane_b32 s90, v56, 63
    s_nop 1
    v_subrev_f32 v57, s90, v20
    v_exp_f32 v57, v57
    s_nop 0
    v_mul_f32 v58, v57, v21
    v_mul_f32 v16, v57, v16
    v_mul_f32 v17, v57, v17
    v_mul_f32 v18, v57, v18
    v_mul_f32 v19, v57, v19
    v_add_f32_dpp v58, v58, v58 row_ror:8 row_mask:0xf bank_mask:0xf
    v_add_f32_dpp v16, v16, v16 row_ror:8 row_mask:0xf bank_mask:0xf
    v_add_f32_dpp v17, v17, v17 row_ror:8 row_mask:0xf bank_mask:0xf
    v_add_f32_dpp v18, v18, v18 row_ror:8 row_mask:0xf bank_mask:0xf
    v_add_f32_dpp v19, v19, v19 row_ror:8 row_mask:0xf bank_mask:0xf
    v_add_f32_dpp v58, v58, v58 row_bcast:15 row_mask:0xa bank_mask:0xf
    v_permlane32_swap_b32 v16, v18
    v_permlane32_swap_b32 v17, v19
    v_add_f32_dpp v58, v58, v58 row_bcast:31 row_mask:0xc bank_mask:0xf
    v_add_f32 v16, v16, v18
    v_add_f32 v17, v17, v19
    v_readlane_b32 s90, v58, 63
    s_nop 0
    v_permlane16_swap_b32 v16, v17
    v_rcp_f32 v58, s90
    v_add_f32 v16, v16, v17
    v_mul_f32 v16, v16, v58
    v_cvt_pk_bf16_f32 v14, v16, v16
    s_waitcnt lgkmcnt(0)
    v_mov_b32 v56, 0
    v_mov_b32 v57, 0
    v_mov_b32 v58, 0
    v_mov_b32 v59, 0
    v_and_b32_dpp v16, v14, v60 row_newbcast:0 row_mask:0xf bank_mask:0xf
    v_and_b32_dpp v17, v14, v61 row_newbcast:0 row_mask:0xf bank_mask:0xf
    v_and_b32_dpp v18, v14, v60 row_newbcast:1 row_mask:0xf bank_mask:0xf
    v_and_b32_dpp v19, v14, v61 row_newbcast:1 row_mask:0xf bank_mask:0xf
    v_and_b32_dpp v20, v14, v60 row_newbcast:2 row_mask:0xf bank_mask:0xf
    v_and_b32_dpp v21, v14, v61 row_newbcast:2 row_mask:0xf bank_mask:0xf
    v_and_b32_dpp v22, v14, v60 row_newbcast:3 row_mask:0xf bank_mask:0xf
    v_and_b32_dpp v23, v14, v61 row_newbcast:3 row_mask:0xf bank_mask:0xf
    v_smfmac_f32_16x16x64_bf16 v[56:59], v[16:19], v[24:31], v62
    v_and_b32_dpp v16, v14, v60 row_newbcast:4 row_mask:0xf bank_mask:0xf
    v_and_b32_dpp v17, v14, v61 row_newbcast:4 row_mask:0xf bank_mask:0xf
    v_and_b32_dpp v18, v14, v60 row_newbcast:5 row_mask:0xf bank_mask:0xf
    v_and_b32_dpp v19, v14, v61 row_newbcast:5 row_mask:0xf bank_mask:0xf
    v_smfmac_f32_16x16x64_bf16 v[56:59], v[20:23], v[32:39], v62
    v_and_b32_dpp v20, v14, v60 row_newbcast:6 row_mask:0xf bank_mask:0xf
    v_and_b32_dpp v21, v14, v61 row_newbcast:6 row_mask:0xf bank_mask:0xf
    v_and_b32_dpp v22, v14, v60 row_newbcast:7 row_mask:0xf bank_mask:0xf
    v_and_b32_dpp v23, v14, v61 row_newbcast:7 row_mask:0xf bank_mask:0xf
    v_smfmac_f32_16x16x64_bf16 v[56:59], v[16:19], v[40:47], v62
    s_nop 0
    v_smfmac_f32_16x16x64_bf16 v[56:59], v[20:23], v[48:55], v62
    s_mov_b32 exec_hi, 1
    s_nop 6
    ds_write_b128 v10, v[56:59] offset:0
    s_mov_b32 exec_hi, -1
    s_waitcnt lgkmcnt(0)
    s_barrier
    s_cmp_lg_u32 s5, 0
    s_cbranch_scc1 ofin_126
    v_add_u32 v11, 156160, v0
    ds_read_b128 v[16:19], v11 offset:0
    ds_read_b128 v[20:23], v11 offset:1056
    ds_read_b128 v[24:27], v11 offset:2112
    ds_read_b128 v[28:31], v11 offset:3168
    s_waitcnt lgkmcnt(0)
    v_add_f32 v16, v16, v20
    v_add_f32 v24, v24, v28
    v_add_f32 v17, v17, v21
    v_add_f32 v25, v25, v29
    v_add_f32 v18, v18, v22
    v_add_f32 v26, v26, v30
    v_add_f32 v19, v19, v23
    v_add_f32 v27, v27, v31
    v_add_f32 v16, v16, v24
    v_add_f32 v17, v17, v25
    v_add_f32 v18, v18, v26
    v_add_f32 v19, v19, v27
    v_perm_b32 v16, v16, v5, s36
    v_perm_b32 v17, v17, v5, s37
    v_perm_b32 v18, v18, v5, s38
    v_perm_b32 v19, v19, v5, s39
    s_mov_b32 exec_lo, 0xfffff
    s_mov_b32 exec_hi, 0x0
    buffer_store_dwordx4 v[16:19], v63, s[8:11], s69 offen sc1
    s_mov_b64 exec, -1
ofin_126:
    s_cmp_lg_u32 s6, 3
    s_cbranch_scc1 keep_127
    s_cmp_lg_u32 s3, 0
    s_cbranch_scc1 L_fin2
keep_127:
    v_lshrrev_b32 v14, 7, v0
    v_lshlrev_b32 v14, 9, v14
    v_and_b32 v15, 0x70, v0
    v_add_u32 v14, v14, v15
    s_lshl_b32 s65, s4, 14
    s_lshl_b32 s66, s5, 7
    s_add_u32 s65, s65, s66
    s_add_u32 s65, s65, s58
    s_add_u32 s66, s65, 4096
    s_add_u32 s67, s65, 8192
    s_add_u32 s68, s65, 12288
    v_lshrrev_b32 v37, 4, v0
    v_and_b32 v38, 1, v37
    v_lshlrev_b32 v38, 4, v38
    v_lshrrev_b32 v39, 1, v37
    v_add_u32 v38, v38, v39
    v_lshlrev_b32 v38, 4, v38
    v_cmp_gt_u32 vcc, 32, v37
    v_mov_b32 v39, 512
    s_nop 0
    v_cndmask_b32 v37, v39, v38, vcc
    s_lshl_b32 s69, s3, 3
    s_add_u32 s69, s69, s4
    s_lshl_b32 s69, s69, 11
    s_add_u32 s69, s69, 1048576
    s_mov_b32 s24, s54
    s_mov_b32 s25, s55
    s_mov_b32 s26, 0x500
    s_mov_b32 s27, 0x20000
    v_lshrrev_b32 v40, 4, v0
    v_and_b32 v41, 15, v40
    v_lshrrev_b32 v40, 4, v40
    v_lshl_add_u32 v40, v41, 2, v40
    s_mul_i32 s90, s4, 80
    s_mul_i32 s91, s5, 20
    s_add_u32 s90, s90, s91
    v_add_u32 v40, s90, v40
    v_lshlrev_b32 v40, 1, v40
    s_mov_b32 s62, 0
    s_cmp_ge_u32 s6, 1
    s_cbranch_scc1 pd_132
    s_cmp_eq_u32 s7, 0
    s_cbranch_scc1 dwn_134
    s_mov_b32 s74, 0
    s_mov_b32 s95, 20
    s_mov_b32 s0, 118
    s_swappc_b64 s[72:73], s[70:71]
    s_branch dwj_135
dwn_134:
    s_waitcnt vmcnt(0)
dwj_135:
    s_barrier
    s_branch pd_133
pd_132:
    s_cmp_lg_u32 s6, 3
    s_cbranch_scc1 pd_136
    s_sleep 10
    s_branch pd_133
pd_136:
    s_sleep 16
pd_133:
    s_mov_b32 exec_lo, 0x1f1f1f1f
    s_mov_b32 exec_hi, 0x1f1f1f1f
poll_128:
    buffer_load_dwordx4 v[16:19], v14, s[8:11], s65 offen sc1
    buffer_load_dwordx4 v[20:23], v14, s[8:11], s66 offen sc1
    buffer_load_dwordx4 v[24:27], v14, s[8:11], s67 offen sc1
    buffer_load_dwordx4 v[28:31], v14, s[8:11], s68 offen sc1
    s_mov_b64 exec, -1
    s_cmp_eq_u32 s7, 0
    s_cbranch_scc1 dwn_137
    s_mov_b32 s74, 0
    s_mov_b32 s95, 24
    s_mov_b32 s0, 118
    s_swappc_b64 s[72:73], s[70:71]
    s_branch dwj_138
dwn_137:
    s_waitcnt vmcnt(0)
dwj_138:
    s_mov_b32 exec_lo, 0x1f1f1f1f
    s_mov_b32 exec_hi, 0x1f1f1f1f
pj_130:
    v_xor_b32 v16, s32, v16
    v_xor_b32 v17, s33, v17
    v_xor_b32 v18, s34, v18
    v_xor_b32 v19, s35, v19
    v_xor_b32 v20, s32, v20
    v_xor_b32 v21, s33, v21
    v_xor_b32 v22, s34, v22
    v_xor_b32 v23, s35, v23
    v_xor_b32 v24, s32, v24
    v_xor_b32 v25, s33, v25
    v_xor_b32 v26, s34, v26
    v_xor_b32 v27, s35, v27
    v_xor_b32 v28, s32, v28
    v_xor_b32 v29, s33, v29
    v_xor_b32 v30, s34, v30
    v_xor_b32 v31, s35, v31
    v_or3_b32 v11, v16, v17, v18
    v_or3_b32 v12, v19, v20, v21
    v_or3_b32 v11, v11, v22, v23
    v_or3_b32 v12, v12, v24, v25
    v_or3_b32 v11, v11, v26, v27
    v_or3_b32 v12, v12, v28, v29
    v_or3_b32 v11, v11, v30, v31
    v_or_b32 v11, v11, v12
    v_and_b32 v11, s64, v11
    v_cmp_ne_u32 vcc, 0, v11
    s_cbranch_vccz pdone_131
    s_add_u32 s62, s62, 1
    s_cmp_lt_u32 s62, 65536
    s_cbranch_scc1 poll_128
    s_mov_b32 s88, 1
pdone_131:
    s_mov_b64 exec, -1
    v_add_f32 v16, v16, v20
    v_add_f32 v24, v24, v28
    v_add_f32 v17, v17, v21
    v_add_f32 v25, v25, v29
    v_add_f32 v18, v18, v22
    v_add_f32 v26, v26, v30
    v_add_f32 v19, v19, v23
    v_add_f32 v27, v27, v31
    v_add_f32 v16, v16, v24
    v_add_f32 v17, v17, v25
    v_add_f32 v18, v18, v26
    v_add_f32 v19, v19, v27
    v_add_f32_dpp v16, v16, v16 row_ror:8 row_mask:0xf bank_mask:0xf
    v_add_f32_dpp v17, v17, v17 row_ror:8 row_mask:0xf bank_mask:0xf
    v_add_f32_dpp v18, v18, v18 row_ror:8 row_mask:0xf bank_mask:0xf
    v_add_f32_dpp v19, v19, v19 row_ror:8 row_mask:0xf bank_mask:0xf
    s_nop 0
    v_permlane32_swap_b32 v16, v18
    v_permlane32_swap_b32 v17, v19
    v_add_f32 v16, v16, v18
    v_add_f32 v17, v17, v19
    s_nop 1
    v_permlane16_swap_b32 v16, v17
    v_add_f32 v16, v16, v17
    v_add_f32 v16, v16, v6
    v_cndmask_b32 v6, 0, v16, s[84:85]
    s_add_u32 s6, s6, 1
    s_xor_b32 s58, s58, 0x20000
    s_cmp_ge_u32 s6, 4
    s_cbranch_scc1 L_done
    s_mul_i32 s97, s97, 0x9E3779B1
    s_add_u32 s97, s97, 0x7F4A7C15
    v_mov_b32 v5, s97
    s_and_b32 s32, s97, 0xff
    s_bfe_u32 s33, s97, 0x80008
    s_bfe_u32 s34, s97, 0x80010
    s_lshr_b32 s35, s97, 24
    s_branch L_layer
L_done:
    s_cmp_lg_u32 s3, 0
    s_cbranch_scc1 fin_139
    v_cvt_pk_bf16_f32 v15, v6, v6
    s_mov_b64 exec, s[84:85]
    buffer_store_short v15, v40, s[24:27], 0 offen
    s_mov_b64 exec, -1
    s_cmp_lg_u32 s2, 0
    s_cbranch_scc1 fin_139
    s_cmp_lg_u32 s5, 0
    s_cbranch_scc1 fin_139
    v_mov_b32 v14, 0
    s_mov_b64 exec, 1
    buffer_store_dword v5, v14, s[8:11], 0 offen sc1
    s_mov_b64 exec, -1
fin_139:
L_fin2:
    s_cmp_eq_u32 s88, 0
    s_cbranch_scc1 noerr_140
    s_mov_b32 s24, s86
    s_mov_b32 s25, s87
    s_mov_b32 s26, 0x100
    s_mov_b32 s27, 0x20000
    v_mov_b32 v14, 0
    v_mov_b32 v15, 0xdead
    s_mov_b64 exec, 1
    buffer_store_dword v15, v14, s[24:27], 0 offen
    s_mov_b64 exec, -1
noerr_140:
    s_waitcnt vmcnt(0)
L_end:
    s_endpgm
L_dw:
    s_getreg_b32 s75, hwreg(HW_REG_IB_STS)
    s_bfe_u32 s94, s75, 0x20016
    s_and_b32 s75, s75, 15
    s_lshl4_add_u32 s75, s94, s75
    s_cmp_le_u32 s75, s74
    s_cbranch_scc1 L_dwret
    s_cmp_ge_u32 s75, s95
    s_cbranch_scc1 L_dw
    s_cmp_eq_u32 s7, 0
    s_cbranch_scc1 L_dw
    s_cmp_ge_u32 s63, s0
    s_cbranch_scc1 L_dw
    s_swappc_b64 s[30:31], s[28:29]
    s_add_u32 s74, s74, 2
    s_branch L_dw
L_dwret:
    s_setpc_b64 s[72:73]
L_stream:
    v_xor_b32 v11, 0, v0
    s_lshl_b32 s61, s5, 14
    s_add_u32 m0, s61, 65536
    s_mov_b32 s61, 0
    buffer_load_dwordx4 v11, s[24:27], s61 offen  lds
    v_xor_b32 v11, 32, v0
    s_lshl_b32 s61, s5, 14
    s_add_u32 m0, s61, 66560
    s_mov_b32 s61, 1024
    buffer_load_dwordx4 v11, s[24:27], s61 offen  lds
    s_add_u32 s63, s63, 2
    s_swappc_b64 s[28:29], s[30:31]
    v_xor_b32 v11, 64, v0
    s_lshl_b32 s61, s5, 14
    s_add_u32 m0, s61, 67584
    s_mov_b32 s61, 2048
    buffer_load_dwordx4 v11, s[24:27], s61 offen  lds
    v_xor_b32 v11, 96, v0
    s_lshl_b32 s61, s5, 14
    s_add_u32 m0, s61, 68608
    s_mov_b32 s61, 3072
    buffer_load_dwordx4 v11, s[24:27], s61 offen  lds
    s_add_u32 s63, s63, 2
    s_swappc_b64 s[28:29], s[30:31]
    v_xor_b32 v11, 16, v0
    s_lshl_b32 s61, s5, 14
    s_add_u32 m0, s61, 69632
    s_mov_b32 s61, 4096
    buffer_load_dwordx4 v11, s[24:27], s61 offen  lds
    v_xor_b32 v11, 48, v0
    s_lshl_b32 s61, s5, 14
    s_add_u32 m0, s61, 70656
    s_mov_b32 s61, 5120
    buffer_load_dwordx4 v11, s[24:27], s61 offen  lds
    s_add_u32 s63, s63, 2
    s_swappc_b64 s[28:29], s[30:31]
    v_xor_b32 v11, 80, v0
    s_lshl_b32 s61, s5, 14
    s_add_u32 m0, s61, 71680
    s_mov_b32 s61, 6144
    buffer_load_dwordx4 v11, s[24:27], s61 offen  lds
    v_xor_b32 v11, 112, v0
    s_lshl_b32 s61, s5, 14
    s_add_u32 m0, s61, 72704
    s_mov_b32 s61, 7168
    buffer_load_dwordx4 v11, s[24:27], s61 offen  lds
    s_add_u32 s63, s63, 2
    s_swappc_b64 s[28:29], s[30:31]
    v_xor_b32 v11, 128, v0
    s_lshl_b32 s61, s5, 14
    s_add_u32 m0, s61, 73728
    s_mov_b32 s61, 8192
    buffer_load_dwordx4 v11, s[24:27], s61 offen  lds
    v_xor_b32 v11, 160, v0
    s_lshl_b32 s61, s5, 14
    s_add_u32 m0, s61, 74752
    s_mov_b32 s61, 9216
    buffer_load_dwordx4 v11, s[24:27], s61 offen  lds
    s_add_u32 s63, s63, 2
    s_swappc_b64 s[28:29], s[30:31]
    v_xor_b32 v11, 192, v0
    s_lshl_b32 s61, s5, 14
    s_add_u32 m0, s61, 75776
    s_mov_b32 s61, 10240
    buffer_load_dwordx4 v11, s[24:27], s61 offen  lds
    v_xor_b32 v11, 224, v0
    s_lshl_b32 s61, s5, 14
    s_add_u32 m0, s61, 76800
    s_mov_b32 s61, 11264
    buffer_load_dwordx4 v11, s[24:27], s61 offen  lds
    s_add_u32 s63, s63, 2
    s_swappc_b64 s[28:29], s[30:31]
    v_xor_b32 v11, 144, v0
    s_lshl_b32 s61, s5, 14
    s_add_u32 m0, s61, 77824
    s_mov_b32 s61, 12288
    buffer_load_dwordx4 v11, s[24:27], s61 offen  lds
    v_xor_b32 v11, 176, v0
    s_lshl_b32 s61, s5, 14
    s_add_u32 m0, s61, 78848
    s_mov_b32 s61, 13312
    buffer_load_dwordx4 v11, s[24:27], s61 offen  lds
    s_add_u32 s63, s63, 2
    s_swappc_b64 s[28:29], s[30:31]
    v_xor_b32 v11, 208, v0
    s_lshl_b32 s61, s5, 14
    s_add_u32 m0, s61, 79872
    s_mov_b32 s61, 14336
    buffer_load_dwordx4 v11, s[24:27], s61 offen  lds
    v_xor_b32 v11, 240, v0
    s_lshl_b32 s61, s5, 14
    s_add_u32 m0, s61, 80896
    s_mov_b32 s61, 15360
    buffer_load_dwordx4 v11, s[24:27], s61 offen  lds
    s_add_u32 s63, s63, 2
    s_swappc_b64 s[28:29], s[30:31]
    v_lshlrev_b32 v11, 2, v0
    s_add_u32 s61, s56, 0
    buffer_load_dword v255, v11, s[8:11], s61 offen
    v_lshlrev_b32 v11, 2, v0
    s_add_u32 s61, s56, 32
    buffer_load_dword v255, v11, s[8:11], s61 offen
    s_add_u32 s63, s63, 2
    s_swappc_b64 s[28:29], s[30:31]
    s_mov_b32 s61, 0
    buffer_load_dwordx4 a[0:3], v8, s[12:15], s61 offen offset:0 nt
    buffer_load_dwordx4 a[4:7], v8, s[12:15], s61 offen offset:1024 nt
    s_add_u32 s63, s63, 2
    s_swappc_b64 s[28:29], s[30:31]
    s_mov_b32 s61, 0
    buffer_load_dwordx4 a[8:11], v8, s[12:15], s61 offen offset:2048 nt
    buffer_load_dwordx4 a[12:15], v8, s[12:15], s61 offen offset:3072 nt
    s_add_u32 s63, s63, 2
    s_swappc_b64 s[28:29], s[30:31]
    s_mov_b32 s61, 4096
    buffer_load_dwordx4 a[16:19], v8, s[12:15], s61 offen offset:0 nt
    buffer_load_dwordx4 a[20:23], v8, s[12:15], s61 offen offset:1024 nt
    s_add_u32 s63, s63, 2
    s_swappc_b64 s[28:29], s[30:31]
    s_mov_b32 s61, 4096
    buffer_load_dwordx4 a[24:27], v8, s[12:15], s61 offen offset:2048 nt
    buffer_load_dwordx4 a[28:31], v8, s[12:15], s61 offen offset:3072 nt
    s_add_u32 s63, s63, 2
    s_swappc_b64 s[28:29], s[30:31]
    s_mov_b32 s61, 8192
    buffer_load_dwordx4 a[32:35], v8, s[12:15], s61 offen offset:0 nt
    buffer_load_dwordx4 a[36:39], v8, s[12:15], s61 offen offset:1024 nt
    s_add_u32 s63, s63, 2
    s_swappc_b64 s[28:29], s[30:31]
    s_mov_b32 s61, 8192
    buffer_load_dwordx4 a[40:43], v8, s[12:15], s61 offen offset:2048 nt
    buffer_load_dwordx4 a[44:47], v8, s[12:15], s61 offen offset:3072 nt
    s_add_u32 s63, s63, 2
    s_swappc_b64 s[28:29], s[30:31]
    s_mov_b32 s61, 12288
    buffer_load_dwordx4 a[48:51], v8, s[12:15], s61 offen offset:0 nt
    buffer_load_dwordx4 a[52:55], v8, s[12:15], s61 offen offset:1024 nt
    s_add_u32 s63, s63, 2
    s_swappc_b64 s[28:29], s[30:31]
    s_mov_b32 s61, 12288
    buffer_load_dwordx4 a[56:59], v8, s[12:15], s61 offen offset:2048 nt
    buffer_load_dwordx4 a[60:63], v8, s[12:15], s61 offen offset:3072 nt
    s_add_u32 s63, s63, 2
    s_swappc_b64 s[28:29], s[30:31]
    s_mov_b32 s61, 16384
    buffer_load_dwordx4 a[64:67], v8, s[12:15], s61 offen offset:0 nt
    buffer_load_dwordx4 a[68:71], v8, s[12:15], s61 offen offset:1024 nt
    s_add_u32 s63, s63, 2
    s_swappc_b64 s[28:29], s[30:31]
    s_mov_b32 s61, 16384
    buffer_load_dwordx4 a[72:75], v8, s[12:15], s61 offen offset:2048 nt
    buffer_load_dwordx4 a[76:79], v8, s[12:15], s61 offen offset:3072 nt
    s_add_u32 s63, s63, 2
    s_swappc_b64 s[28:29], s[30:31]
    s_mov_b32 s61, 20480
    buffer_load_dwordx4 a[80:83], v8, s[12:15], s61 offen offset:0 nt
    buffer_load_dwordx4 a[84:87], v8, s[12:15], s61 offen offset:1024 nt
    s_add_u32 s63, s63, 2
    s_swappc_b64 s[28:29], s[30:31]
    s_mov_b32 s61, 20480
    buffer_load_dwordx4 a[88:91], v8, s[12:15], s61 offen offset:2048 nt
    buffer_load_dwordx4 a[92:95], v8, s[12:15], s61 offen offset:3072 nt
    s_add_u32 s63, s63, 2
    s_swappc_b64 s[28:29], s[30:31]
    s_mov_b32 s61, 24576
    buffer_load_dwordx4 a[96:99], v8, s[12:15], s61 offen offset:0 nt
    buffer_load_dwordx4 a[100:103], v8, s[12:15], s61 offen offset:1024 nt
    s_add_u32 s63, s63, 2
    s_swappc_b64 s[28:29], s[30:31]
    s_mov_b32 s61, 24576
    buffer_load_dwordx4 a[104:107], v8, s[12:15], s61 offen offset:2048 nt
    buffer_load_dwordx4 a[108:111], v8, s[12:15], s61 offen offset:3072 nt
    s_add_u32 s63, s63, 2
    s_swappc_b64 s[28:29], s[30:31]
    s_mov_b32 s61, 28672
    buffer_load_dwordx4 a[112:115], v8, s[12:15], s61 offen offset:0 nt
    buffer_load_dwordx4 a[116:119], v8, s[12:15], s61 offen offset:1024 nt
    s_add_u32 s63, s63, 2
    s_swappc_b64 s[28:29], s[30:31]
    s_mov_b32 s61, 28672
    buffer_load_dwordx4 a[120:123], v8, s[12:15], s61 offen offset:2048 nt
    buffer_load_dwordx4 a[124:127], v8, s[12:15], s61 offen offset:3072 nt
    s_add_u32 s63, s63, 2
    s_swappc_b64 s[28:29], s[30:31]
    s_mov_b32 s61, 32768
    buffer_load_dwordx4 a[128:131], v8, s[12:15], s61 offen offset:0 nt
    buffer_load_dwordx4 a[132:135], v8, s[12:15], s61 offen offset:1024 nt
    s_add_u32 s63, s63, 2
    s_swappc_b64 s[28:29], s[30:31]
    s_mov_b32 s61, 32768
    buffer_load_dwordx4 a[136:139], v8, s[12:15], s61 offen offset:2048 nt
    buffer_load_dwordx4 a[140:143], v8, s[12:15], s61 offen offset:3072 nt
    s_add_u32 s63, s63, 2
    s_swappc_b64 s[28:29], s[30:31]
    s_mov_b32 s61, 36864
    buffer_load_dwordx4 a[144:147], v8, s[12:15], s61 offen offset:0 nt
    buffer_load_dwordx4 a[148:151], v8, s[12:15], s61 offen offset:1024 nt
    s_add_u32 s63, s63, 2
    s_swappc_b64 s[28:29], s[30:31]
    s_mov_b32 s61, 36864
    buffer_load_dwordx4 a[152:155], v8, s[12:15], s61 offen offset:2048 nt
    buffer_load_dwordx4 a[156:159], v8, s[12:15], s61 offen offset:3072 nt
    s_add_u32 s63, s63, 2
    s_swappc_b64 s[28:29], s[30:31]
    s_mov_b32 s61, 40960
    buffer_load_dwordx4 a[160:163], v8, s[12:15], s61 offen offset:0 nt
    buffer_load_dwordx4 a[164:167], v8, s[12:15], s61 offen offset:1024 nt
    s_add_u32 s63, s63, 2
    s_swappc_b64 s[28:29], s[30:31]
    s_mov_b32 s61, 40960
    buffer_load_dwordx4 a[168:171], v8, s[12:15], s61 offen offset:2048 nt
    buffer_load_dwordx4 a[172:175], v8, s[12:15], s61 offen offset:3072 nt
    s_add_u32 s63, s63, 2
    s_swappc_b64 s[28:29], s[30:31]
    s_mov_b32 s61, 45056
    buffer_load_dwordx4 a[176:179], v8, s[12:15], s61 offen offset:0 nt
    buffer_load_dwordx4 a[180:183], v8, s[12:15], s61 offen offset:1024 nt
    s_add_u32 s63, s63, 2
    s_swappc_b64 s[28:29], s[30:31]
    s_mov_b32 s61, 45056
    buffer_load_dwordx4 a[184:187], v8, s[12:15], s61 offen offset:2048 nt
    buffer_load_dwordx4 a[188:191], v8, s[12:15], s61 offen offset:3072 nt
    s_add_u32 s63, s63, 2
    s_swappc_b64 s[28:29], s[30:31]
    s_mov_b32 s61, 49152
    buffer_load_dwordx4 a[192:195], v8, s[12:15], s61 offen offset:0 nt
    buffer_load_dwordx4 a[196:199], v8, s[12:15], s61 offen offset:1024 nt
    s_add_u32 s63, s63, 2
    s_swappc_b64 s[28:29], s[30:31]
    s_mov_b32 s61, 49152
    buffer_load_dwordx4 a[200:203], v8, s[12:15], s61 offen offset:2048 nt
    buffer_load_dwordx4 a[204:207], v8, s[12:15], s61 offen offset:3072 nt
    s_add_u32 s63, s63, 2
    s_swappc_b64 s[28:29], s[30:31]
    s_mov_b32 s61, 53248
    buffer_load_dwordx4 a[208:211], v8, s[12:15], s61 offen offset:0 nt
    buffer_load_dwordx4 a[212:215], v8, s[12:15], s61 offen offset:1024 nt
    s_add_u32 s63, s63, 2
    s_swappc_b64 s[28:29], s[30:31]
    s_mov_b32 s61, 53248
    buffer_load_dwordx4 a[216:219], v8, s[12:15], s61 offen offset:2048 nt
    buffer_load_dwordx4 a[220:223], v8, s[12:15], s61 offen offset:3072 nt
    s_add_u32 s63, s63, 2
    s_swappc_b64 s[28:29], s[30:31]
    s_mov_b32 s61, 57344
    buffer_load_dwordx4 a[224:227], v8, s[12:15], s61 offen offset:0 nt
    buffer_load_dwordx4 a[228:231], v8, s[12:15], s61 offen offset:1024 nt
    s_add_u32 s63, s63, 2
    s_swappc_b64 s[28:29], s[30:31]
    s_mov_b32 s61, 57344
    buffer_load_dwordx4 a[232:235], v8, s[12:15], s61 offen offset:2048 nt
    buffer_load_dwordx4 a[236:239], v8, s[12:15], s61 offen offset:3072 nt
    s_add_u32 s63, s63, 2
    s_swappc_b64 s[28:29], s[30:31]
    s_mov_b32 s61, 61440
    buffer_load_dwordx4 a[240:243], v8, s[12:15], s61 offen offset:0 nt
    buffer_load_dwordx4 a[244:247], v8, s[12:15], s61 offen offset:1024 nt
    s_add_u32 s63, s63, 2
    s_swappc_b64 s[28:29], s[30:31]
    s_mov_b32 s61, 61440
    buffer_load_dwordx4 a[248:251], v8, s[12:15], s61 offen offset:2048 nt
    buffer_load_dwordx4 a[252:255], v8, s[12:15], s61 offen offset:3072 nt
    s_add_u32 s63, s63, 2
    s_swappc_b64 s[28:29], s[30:31]
    s_mov_b32 s61, 0
    buffer_load_dwordx4 v[96:99], v9, s[16:19], s61 offen offset:0 nt
    buffer_load_dwordx4 v[100:103], v9, s[16:19], s61 offen offset:2048 nt
    s_add_u32 s63, s63, 2
    s_swappc_b64 s[28:29], s[30:31]
    s_mov_b32 s61, 0
    buffer_load_dwordx4 v[104:107], v9, s[16:19], s61 offen offset:512 nt
    buffer_load_dwordx4 v[108:111], v9, s[16:19], s61 offen offset:2560 nt
    s_add_u32 s63, s63, 2
    s_swappc_b64 s[28:29], s[30:31]
    s_mov_b32 s61, 4096
    buffer_load_dwordx4 v[112:115], v9, s[16:19], s61 offen offset:0 nt
    buffer_load_dwordx4 v[116:119], v9, s[16:19], s61 offen offset:2048 nt
    s_add_u32 s63, s63, 2
    s_swappc_b64 s[28:29], s[30:31]
    s_mov_b32 s61, 4096
    buffer_load_dwordx4 v[120:123], v9, s[16:19], s61 offen offset:512 nt
    buffer_load_dwordx4 v[124:127], v9, s[16:19], s61 offen offset:2560 nt
    s_add_u32 s63, s63, 2
    s_swappc_b64 s[28:29], s[30:31]
    s_mov_b32 s61, 8192
    buffer_load_dwordx4 v[128:131], v9, s[16:19], s61 offen offset:0 nt
    buffer_load_dwordx4 v[132:135], v9, s[16:19], s61 offen offset:2048 nt
    s_add_u32 s63, s63, 2
    s_swappc_b64 s[28:29], s[30:31]
    s_mov_b32 s61, 8192
    buffer_load_dwordx4 v[136:139], v9, s[16:19], s61 offen offset:512 nt
    buffer_load_dwordx4 v[140:143], v9, s[16:19], s61 offen offset:2560 nt
    s_add_u32 s63, s63, 2
    s_swappc_b64 s[28:29], s[30:31]
    s_mov_b32 s61, 12288
    buffer_load_dwordx4 v[144:147], v9, s[16:19], s61 offen offset:0 nt
    buffer_load_dwordx4 v[148:151], v9, s[16:19], s61 offen offset:2048 nt
    s_add_u32 s63, s63, 2
    s_swappc_b64 s[28:29], s[30:31]
    s_mov_b32 s61, 12288
    buffer_load_dwordx4 v[152:155], v9, s[16:19], s61 offen offset:512 nt
    buffer_load_dwordx4 v[156:159], v9, s[16:19], s61 offen offset:2560 nt
    s_add_u32 s63, s63, 2
    s_swappc_b64 s[28:29], s[30:31]
    s_mov_b32 s61, 16384
    buffer_load_dwordx4 v[160:163], v9, s[16:19], s61 offen offset:0 nt
    buffer_load_dwordx4 v[164:167], v9, s[16:19], s61 offen offset:2048 nt
    s_add_u32 s63, s63, 2
    s_swappc_b64 s[28:29], s[30:31]
    s_mov_b32 s61, 16384
    buffer_load_dwordx4 v[168:171], v9, s[16:19], s61 offen offset:512 nt
    buffer_load_dwordx4 v[172:175], v9, s[16:19], s61 offen offset:2560 nt
    s_add_u32 s63, s63, 2
    s_swappc_b64 s[28:29], s[30:31]
    s_mov_b32 s61, 20480
    buffer_load_dwordx4 v[176:179], v9, s[16:19], s61 offen offset:0 nt
    buffer_load_dwordx4 v[180:183], v9, s[16:19], s61 offen offset:2048 nt
    s_add_u32 s63, s63, 2
    s_swappc_b64 s[28:29], s[30:31]
    s_mov_b32 s61, 20480
    buffer_load_dwordx4 v[184:187], v9, s[16:19], s61 offen offset:512 nt
    buffer_load_dwordx4 v[188:191], v9, s[16:19], s61 offen offset:2560 nt
    s_add_u32 s63, s63, 2
    s_swappc_b64 s[28:29], s[30:31]
    s_mov_b32 s61, 24576
    buffer_load_dwordx4 v[192:195], v9, s[16:19], s61 offen offset:0 nt
    buffer_load_dwordx4 v[196:199], v9, s[16:19], s61 offen offset:2048 nt
    s_add_u32 s63, s63, 2
    s_swappc_b64 s[28:29], s[30:31]
    s_mov_b32 s61, 24576
    buffer_load_dwordx4 v[200:203], v9, s[16:19], s61 offen offset:512 nt
    buffer_load_dwordx4 v[204:207], v9, s[16:19], s61 offen offset:2560 nt
    s_add_u32 s63, s63, 2
    s_swappc_b64 s[28:29], s[30:31]
    s_mov_b32 s61, 28672
    buffer_load_dwordx4 v[208:211], v9, s[16:19], s61 offen offset:0 nt
    buffer_load_dwordx4 v[212:215], v9, s[16:19], s61 offen offset:2048 nt
    s_add_u32 s63, s63, 2
    s_swappc_b64 s[28:29], s[30:31]
    s_mov_b32 s61, 28672
    buffer_load_dwordx4 v[216:219], v9, s[16:19], s61 offen offset:512 nt
    buffer_load_dwordx4 v[220:223], v9, s[16:19], s61 offen offset:2560 nt
    s_add_u32 s63, s63, 2
    s_swappc_b64 s[28:29], s[30:31]
    s_mov_b32 s61, 32768
    buffer_load_dwordx4 v[224:227], v9, s[16:19], s61 offen offset:0 nt
    buffer_load_dwordx4 v[228:231], v9, s[16:19], s61 offen offset:2048 nt
    s_add_u32 s63, s63, 2
    s_swappc_b64 s[28:29], s[30:31]
    s_mov_b32 s61, 32768
    buffer_load_dwordx4 v[232:235], v9, s[16:19], s61 offen offset:512 nt
    buffer_load_dwordx4 v[236:239], v9, s[16:19], s61 offen offset:2560 nt
    s_add_u32 s63, s63, 2
    s_swappc_b64 s[28:29], s[30:31]
    s_mov_b32 s61, 36864
    buffer_load_dwordx4 v[240:243], v9, s[16:19], s61 offen offset:0 nt
    buffer_load_dwordx4 v[244:247], v9, s[16:19], s61 offen offset:2048 nt
    s_add_u32 s63, s63, 2
    s_swappc_b64 s[28:29], s[30:31]
    s_mov_b32 s61, 36864
    buffer_load_dwordx4 v[248:251], v9, s[16:19], s61 offen offset:512 nt
    buffer_load_dwordx4 v[252:255], v9, s[16:19], s61 offen offset:2560 nt
    s_add_u32 s63, s63, 2
    s_swappc_b64 s[28:29], s[30:31]
    s_lshl_b32 s61, s5, 14
    s_add_u32 m0, s61, 0
    s_mov_b32 s61, 40960
    buffer_load_dwordx4 v9, s[16:19], s61 offen nt lds
    s_lshl_b32 s61, s5, 14
    s_add_u32 m0, s61, 1024
    s_mov_b32 s61, 43008
    buffer_load_dwordx4 v9, s[16:19], s61 offen nt lds
    s_add_u32 s63, s63, 2
    s_swappc_b64 s[28:29], s[30:31]
    s_lshl_b32 s61, s5, 14
    s_add_u32 m0, s61, 2048
    s_mov_b32 s61, 41472
    buffer_load_dwordx4 v9, s[16:19], s61 offen nt lds
    s_lshl_b32 s61, s5, 14
    s_add_u32 m0, s61, 3072
    s_mov_b32 s61, 43520
    buffer_load_dwordx4 v9, s[16:19], s61 offen nt lds
    s_add_u32 s63, s63, 2
    s_swappc_b64 s[28:29], s[30:31]
    s_lshl_b32 s61, s5, 14
    s_add_u32 m0, s61, 4096
    s_mov_b32 s61, 45056
    buffer_load_dwordx4 v9, s[16:19], s61 offen nt lds
    s_lshl_b32 s61, s5, 14
    s_add_u32 m0, s61, 5120
    s_mov_b32 s61, 47104
    buffer_load_dwordx4 v9, s[16:19], s61 offen nt lds
    s_add_u32 s63, s63, 2
    s_swappc_b64 s[28:29], s[30:31]
    s_lshl_b32 s61, s5, 14
    s_add_u32 m0, s61, 6144
    s_mov_b32 s61, 45568
    buffer_load_dwordx4 v9, s[16:19], s61 offen nt lds
    s_lshl_b32 s61, s5, 14
    s_add_u32 m0, s61, 7168
    s_mov_b32 s61, 47616
    buffer_load_dwordx4 v9, s[16:19], s61 offen nt lds
    s_add_u32 s63, s63, 2
    s_swappc_b64 s[28:29], s[30:31]
    s_lshl_b32 s61, s5, 14
    s_add_u32 m0, s61, 8192
    s_mov_b32 s61, 49152
    buffer_load_dwordx4 v9, s[16:19], s61 offen nt lds
    s_lshl_b32 s61, s5, 14
    s_add_u32 m0, s61, 9216
    s_mov_b32 s61, 51200
    buffer_load_dwordx4 v9, s[16:19], s61 offen nt lds
    s_add_u32 s63, s63, 2
    s_swappc_b64 s[28:29], s[30:31]
    s_lshl_b32 s61, s5, 14
    s_add_u32 m0, s61, 10240
    s_mov_b32 s61, 49664
    buffer_load_dwordx4 v9, s[16:19], s61 offen nt lds
    s_lshl_b32 s61, s5, 14
    s_add_u32 m0, s61, 11264
    s_mov_b32 s61, 51712
    buffer_load_dwordx4 v9, s[16:19], s61 offen nt lds
    s_add_u32 s63, s63, 2
    s_swappc_b64 s[28:29], s[30:31]
    s_lshl_b32 s61, s5, 14
    s_add_u32 m0, s61, 12288
    s_mov_b32 s61, 53248
    buffer_load_dwordx4 v9, s[16:19], s61 offen nt lds
    s_lshl_b32 s61, s5, 14
    s_add_u32 m0, s61, 13312
    s_mov_b32 s61, 55296
    buffer_load_dwordx4 v9, s[16:19], s61 offen nt lds
    s_add_u32 s63, s63, 2
    s_swappc_b64 s[28:29], s[30:31]
    s_lshl_b32 s61, s5, 14
    s_add_u32 m0, s61, 14336
    s_mov_b32 s61, 53760
    buffer_load_dwordx4 v9, s[16:19], s61 offen nt lds
    s_lshl_b32 s61, s5, 14
    s_add_u32 m0, s61, 15360
    s_mov_b32 s61, 55808
    buffer_load_dwordx4 v9, s[16:19], s61 offen nt lds
    s_add_u32 s63, s63, 2
    s_mov_b32 s7, 0
    s_swappc_b64 s[28:29], s[30:31]
    s_endpgm
L_codeend:
.section .rodata,"a"
.p2align 6
.amdhsa_kernel interleave_layers__compressed_kv_cla__mha_block_cached__decode_kernel
  .amdhsa_next_free_vgpr 512
  .amdhsa_next_free_sgpr 102
  .amdhsa_accum_offset 256
  .amdhsa_group_segment_fixed_size 0
  .amdhsa_kernarg_size 112
  .amdhsa_user_sgpr_count 2
  .amdhsa_user_sgpr_kernarg_segment_ptr 1
  .amdhsa_system_sgpr_workgroup_id_x 1
  .amdhsa_float_denorm_mode_32 3
.end_amdhsa_kernel
```
